```python
import torch

def _softmax(x, axis=-1):
    return torch.softmax(x, dim=axis)
def _gelu(x):
    return torch.nn.functional.gelu(x, approximate="tanh")
def _silu(x):
    return torch.nn.functional.silu(x)
def _sigmoid(x):
    return torch.sigmoid(x)
def _layernorm(x, axis=-1, eps=1e-5):
    m = x.mean(dim=axis, keepdim=True)
    v = x.var(dim=axis, keepdim=True, unbiased=False)
    return (x - m) / torch.sqrt(v + eps)
def _scatter_add(tgt, idx, src, axis=0):
    return tgt.clone().index_add_(axis, idx, src)
def _segment_sum(src, seg, n):
    out = torch.zeros((n,) + src.shape[1:], dtype=src.dtype)
    return out.index_add_(0, seg, src)
def _pad(x, pw):
    flat = tuple(v for pair in reversed(pw) for v in pair)
    return torch.nn.functional.pad(x, flat)

kernel_name = 'standalone__dense_activation_silu__prompt'

def setup_inputs():

    _w = (lambda a: (lambda t: t.to(torch.bfloat16) if t.is_floating_point() else t)(torch.as_tensor(a)))
    B, S, D, F = 1, 2048, 1024, 3584
    return {
        "x": _w((lambda *s: torch.randn(*s, dtype=torch.bfloat16) * 0.1)(B, S, D)),
        "w1": _w((lambda *s: torch.randn(*s, dtype=torch.bfloat16) * 3.2)(D, F) * (D ** -0.5)),
        "w2": _w((lambda *s: torch.randn(*s, dtype=torch.bfloat16) * 3.2)(F, D) * (F ** -0.5)),
    }

def reference(x, w1, w2):
    h = torch.einsum("bsd,df->bsf", x, w1)
    h = _silu(h)
    out = torch.einsum("bsf,fd->bsd", h, w2)
    return out
```

```asm
; @launch grid=(256,1,1) block=(512,1,1) lds=151552
.amdgcn_target "amdgcn-amd-amdhsa--gfx950"
.text
.globl standalone__dense_activation_silu__prompt_kernel
.p2align 8
.type standalone__dense_activation_silu__prompt_kernel,@function
standalone__dense_activation_silu__prompt_kernel:
s_load_dwordx8 s[4:11], s[0:1], 0
s_load_dwordx4 s[12:15], s[0:1], 32
s_cmp_ge_u32 s2, 256
s_cbranch_scc1 L_end
s_getpc_b64 s[54:55]
C_pc:
v_lshlrev_b32 v3, 7, v0
s_sub_u32 s54, s54, C_pc-standalone__dense_activation_silu__prompt_kernel
s_subb_u32 s55, s55, 0
s_cmp_lt_u32 s2, 16
s_cselect_b32 s3, L_end-standalone__dense_activation_silu__prompt_kernel, 0
v_min_u32 v3, s3, v3
v_lshrrev_b32 v1, 6, v0
global_load_dword v255, v3, s[54:55]
v_and_b32 v2, 63, v0
v_readfirstlane_b32 s3, v1
s_and_b32 s45, s2, 7
s_lshr_b32 s46, s2, 3
s_lshr_b32 s40, s45, 1
s_lshl_b32 s40, s40, 2
s_lshr_b32 s47, s46, 3
s_add_u32 s40, s40, s47
s_and_b32 s41, s45, 1
s_and_b32 s42, s46, 7
s_lshl_b32 s43, s41, 3
s_add_u32 s43, s43, s42
s_lshl_b32 s44, s40, 4
s_add_u32 s44, s44, s43
s_mov_b32 s63, s42
s_cmp_lt_u32 s3, 4
s_cbranch_scc0 L_prod
s_lshr_b32 s58, s45, 1
s_lshl_b32 s59, s58, 2
s_lshl_b32 s58, s58, 5
s_add_u32 s58, s58, s46
s_lshl_b32 s58, s58, 1
s_add_u32 s58, s58, s41
s_lshl_b32 s58, s58, 14
v_bfe_u32 v15, v0, 2, 3
v_add_u32 v15, s59, v15
v_and_b32 v15, 15, v15
v_lshlrev_b32 v15, 7, v15
v_lshrrev_b32 v14, 5, v0
v_lshl_add_u32 v15, v14, 11, v15
v_add_u32 v252, s58, v15
s_waitcnt lgkmcnt(0)
global_load_dword v253, v252, s[4:5]
s_branch L_cons
L_prod:
s_sub_u32 s46, s3, 4
s_setprio 3
v_lshrrev_b32 v3, 3, v2
v_and_b32 v4, 7, v2
v_lshrrev_b32 v5, 4, v2
v_xor_b32 v4, v4, v5
v_lshlrev_b32 v4, 4, v4
v_lshl_add_u32 v3, v3, 11, v4
s_lshl_b32 s53, s40, 18
s_lshl_b32 s54, s46, 16
s_add_u32 s53, s53, s54
v_add_u32 v8, s53, v3
v_xor_b32 v9, 64, v8
v_add_u32 v9, 0x4000, v9
v_add_u32 v10, 0x8000, v8
v_add_u32 v11, 0x8000, v9
s_lshr_b32 s53, s45, 1
s_lshl_b32 s53, s53, 2
s_mov_b32 s62, s53
s_and_b32 s54, s40, 1
s_lshl_b32 s54, s54, 1
s_add_u32 s53, s53, s54
s_lshl_b32 s47, s53, 7
s_mul_i32 s48, s53, 458752
s_lshl_b32 s49, s46, 12
s_mov_b32 s57, 0
s_mov_b32 s18, 4194304
s_mov_b32 s19, 0x20000
s_waitcnt lgkmcnt(0)
s_mov_b32 s16, s4
s_and_b32 s17, s5, 0xffff
s_add_u32 m0, s57, s49
s_add_u32 s57, s57, 16384
buffer_load_dwordx4 v8, s[16:19], s47 offen  lds
s_add_u32 m0, m0, 1024
s_and_b32 s57, s57, 0xffff
buffer_load_dwordx4 v9, s[16:19], s47 offen  lds
s_add_u32 m0, m0, 1024
s_nop 0
buffer_load_dwordx4 v10, s[16:19], s47 offen  lds
s_add_u32 m0, m0, 1024
s_nop 0
buffer_load_dwordx4 v11, s[16:19], s47 offen  lds
s_and_b32 s53, s42, 1
s_lshl_b32 s54, s53, 6
v_bfe_u32 v3, v2, 2, 3
v_mul_u32_u24 v3, 7168, v3
v_lshrrev_b32 v5, 5, v2
v_and_b32 v4, 3, v2
v_lshlrev_b32 v4, 4, v4
v_lshl_add_u32 v6, v5, 6, v3
v_add3_u32 v13, v6, v4, s54
v_xor_b32 v14, 32, v13
v_add_u32 v14, 57344, v14
s_xor_b32 s53, s53, 1
s_mul_i32 s53, s53, 384
v_lshrrev_b32 v3, 2, v2
v_mul_u32_u24 v3, 7168, v3
v_lshlrev_b32 v5, 5, v5
v_xor_b32 v4, v4, v5
v_add3_u32 v12, v3, v4, s53
s_mul_i32 s59, s46, 114688
s_mul_i32 s53, s43, 448
s_add_u32 s59, s59, s53
s_add_u32 s48, s48, s59
s_mul_i32 s50, s46, 7168
s_add_u32 s50, s50, 65536
s_mov_b32 s51, 57344
s_mov_b32 s20, s6
s_and_b32 s21, s7, 0xffff
s_mov_b32 s22, 7340032
s_mov_b32 s23, 0x20000
s_add_u32 m0, s51, s50
s_add_u32 s51, s51, 28672
buffer_load_dwordx4 v13, s[20:23], s48 offen offset:0  lds
s_add_u32 m0, m0, 1024
s_cmp_eq_u32 s51, 86016
s_cselect_b32 s51, 0, s51
buffer_load_dwordx4 v14, s[20:23], s48 offen offset:0  lds
s_add_u32 m0, m0, 896
s_nop 0
buffer_load_dwordx4 v13, s[20:23], s48 offen offset:128  lds
s_add_u32 m0, m0, 1024
s_nop 0
buffer_load_dwordx4 v14, s[20:23], s48 offen offset:128  lds
s_add_u32 s1, m0, 896
s_mov_b32 s24, s8
s_and_b32 s25, s9, 0xffff
s_mov_b32 s26, 7340032
s_mov_b32 s27, 0x20000
s_mov_b32 s36, s14
s_and_b32 s37, s15, 0xffff
s_mov_b32 s38, 268435456
s_mov_b32 s39, 0x20000
s_lshr_b32 s4, s44, 3
s_lshl_b32 s4, s4, 10
s_add_u32 s4, s4, 50332416
s_add_u32 s4, s14, s4
s_addc_u32 s5, s15, 0
s_lshl_b32 s6, s40, 4
s_add_u32 s6, s12, s6
s_addc_u32 s7, s13, 0
s_lshr_b32 s55, s46, 1
s_and_b32 s56, s46, 1
v_subrev_u32 v5, 3, v2
v_mul_u32_u24 v3, 37, v5
v_lshrrev_b32 v3, 8, v3
v_mul_u32_u24 v4, 7, v3
v_sub_u32 v4, v5, v4
v_add_u32 v6, s40, v3
v_and_b32 v6, 3, v6
v_add_u32 v4, v6, v4
v_subrev_u32 v6, 7, v4
v_min_u32 v4, v4, v6
v_add_u32 v4, 1, v4
v_cmp_gt_u32 vcc, 3, v2
s_nop 1
v_cndmask_b32 v3, v3, v2, vcc
v_cndmask_b32 v4, v4, 0, vcc
v_add_u32 v4, s42, v4
v_and_b32 v4, 7, v4
v_and_b32 v6, 1, v4
v_mul_u32_u24 v4, 7, v4
v_lshl_add_u32 v4, v3, 1, v4
v_add3_u32 v4, v4, v6, s55
s_and_b32 s53, s40, 3
v_add_u32 v5, s53, v2
v_and_b32 v5, 3, v5
v_mul_u32_u24 v5, 14, v5
v_add3_u32 v5, v5, 6, s55
v_cmp_gt_u32 vcc, 24, v2
s_nop 1
v_cndmask_b32 v4, v5, v4, vcc
v_and_b32 v4, 63, v4
s_mul_i32 s53, s41, 56
v_add_u32 v4, s53, v4
s_mul_i32 s53, s40, 1146880
s_mul_i32 s54, s56, 5120
s_add_u32 s53, s53, s54
v_mul_u32_u24 v20, 10240, v4
v_add_u32 v20, s53, v20
s_lshl_b32 s53, s56, 15
s_lshl_b32 s54, s56, 13
v_mov_b32 v5, s53
v_mov_b32 v6, s54
v_cndmask_b32 v5, v6, v5, vcc
v_lshl_add_u32 v21, v4, 16, v5
s_lshl_b32 s53, s63, 8
v_add_u32 v21, s53, v21
v_and_b32 v4, 3, v2
v_bfe_u32 v5, v2, 4, 1
v_lshlrev_b32 v6, 1, v5
v_xor_b32 v4, v4, v6
v_lshlrev_b32 v4, 4, v4
v_lshrrev_b32 v6, 5, v2
v_lshl_add_u32 v4, v6, 6, v4
v_bfe_u32 v6, v2, 2, 3
v_lshl_add_u32 v22, v6, 11, v4
v_add_u32 v23, 0x4000, v22
v_lshl_add_u32 v24, v5, 13, v22
v_add_u32 v25, 0x8000, v24
v_and_b32 v6, 7, v2
v_lshlrev_b32 v6, 4, v6
v_lshrrev_b32 v5, 3, v2
v_add_u32 v5, 0, v5
v_add_u32 v4, 4, v5
v_mul_u32_u24 v4, 37, v4
v_lshrrev_b32 v4, 8, v4
v_add_u32 v4, v4, v5
v_lshlrev_b32 v26, 7, v4
v_add_u32 v26, v26, v6
v_lshrrev_b32 v5, 3, v2
v_add_u32 v5, 8, v5
v_add_u32 v4, 4, v5
v_mul_u32_u24 v4, 37, v4
v_lshrrev_b32 v4, 8, v4
v_add_u32 v4, v4, v5
v_lshlrev_b32 v27, 7, v4
v_add_u32 v27, v27, v6
v_lshrrev_b32 v5, 3, v2
v_add_u32 v5, 16, v5
v_add_u32 v4, 4, v5
v_mul_u32_u24 v4, 37, v4
v_lshrrev_b32 v4, 8, v4
v_add_u32 v4, v4, v5
v_lshlrev_b32 v28, 7, v4
v_add_u32 v28, v28, v6
v_lshrrev_b32 v5, 3, v2
v_add_u32 v5, 24, v5
v_add_u32 v4, 4, v5
v_mul_u32_u24 v4, 37, v4
v_lshrrev_b32 v4, 8, v4
v_add_u32 v4, v4, v5
v_lshlrev_b32 v29, 7, v4
v_add_u32 v29, v29, v6
v_bfe_u32 v3, v2, 3, 1
v_xor_b32 v3, s40, v3
v_and_b32 v3, 1, v3
v_lshl_add_u32 v3, v3, 1, v2
v_and_b32 v3, 7, v3
v_and_b32 v4, 8, v2
v_add3_u32 v3, v3, v4, s62
v_and_b32 v3, 15, v3
v_lshlrev_b32 v30, 7, v3
v_mul_u32_u24 v31, 458752, v3
v_add_u32 v31, s59, v31
v_readlane_b32 s47, v30, 1
s_mov_b32 m0, s1
s_nop 0
buffer_load_dwordx4 v13, s[20:23], s48 offen offset:256  lds
s_add_u32 m0, m0, 1024
s_nop 0
buffer_load_dwordx4 v14, s[20:23], s48 offen offset:256  lds
s_add_u32 m0, m0, 1280
s_nop 0
buffer_load_dwordx4 v12, s[20:23], s48 offen  lds
s_add_u32 m0, s57, s49
s_add_u32 s57, s57, 16384
buffer_load_dwordx4 v8, s[16:19], s47 offen  lds
s_add_u32 m0, m0, 1024
v_readlane_b32 s48, v31, 1
buffer_load_dwordx4 v9, s[16:19], s47 offen  lds
s_add_u32 m0, m0, 1024
s_and_b32 s57, s57, 0xffff
buffer_load_dwordx4 v10, s[16:19], s47 offen  lds
s_add_u32 m0, m0, 1024
s_nop 0
buffer_load_dwordx4 v11, s[16:19], s47 offen  lds
s_add_u32 m0, s51, s50
s_add_u32 s51, s51, 28672
buffer_load_dwordx4 v13, s[20:23], s48 offen offset:0  lds
s_add_u32 m0, m0, 1024
s_cmp_eq_u32 s51, 86016
s_cselect_b32 s51, 0, s51
buffer_load_dwordx4 v14, s[20:23], s48 offen offset:0  lds
s_add_u32 m0, m0, 896
s_nop 0
buffer_load_dwordx4 v13, s[20:23], s48 offen offset:128  lds
s_add_u32 m0, m0, 1024
s_nop 0
buffer_load_dwordx4 v14, s[20:23], s48 offen offset:128  lds
s_add_u32 s1, m0, 896
v_readlane_b32 s47, v30, 2
s_waitcnt vmcnt(8)
s_barrier
s_mov_b32 m0, s1
s_nop 0
buffer_load_dwordx4 v13, s[20:23], s48 offen offset:256  lds
s_add_u32 m0, m0, 1024
s_nop 0
buffer_load_dwordx4 v14, s[20:23], s48 offen offset:256  lds
s_add_u32 m0, m0, 1280
s_nop 0
buffer_load_dwordx4 v12, s[20:23], s48 offen  lds
s_add_u32 m0, s57, s49
s_add_u32 s57, s57, 16384
buffer_load_dwordx4 v8, s[16:19], s47 offen  lds
s_add_u32 m0, m0, 1024
v_readlane_b32 s48, v31, 2
buffer_load_dwordx4 v9, s[16:19], s47 offen  lds
s_add_u32 m0, m0, 1024
s_and_b32 s57, s57, 0xffff
buffer_load_dwordx4 v10, s[16:19], s47 offen  lds
s_add_u32 m0, m0, 1024
s_mov_b32 s52, 2
buffer_load_dwordx4 v11, s[16:19], s47 offen  lds
s_mov_b32 s61, 33280
s_add_u32 m0, s51, s50
s_branch P1_w
.p2align 3
P1_loop:
s_bitcmp1_b32 s61, s52
s_cbranch_scc1 P1_hk
P1_hkb:
s_add_u32 m0, s57, s49
s_add_u32 s57, s57, 16384
buffer_load_dwordx4 v8, s[16:19], s47 offen  lds
s_add_u32 m0, m0, 1024
v_readlane_b32 s48, v31, s52
buffer_load_dwordx4 v9, s[16:19], s47 offen  lds
s_add_u32 m0, m0, 1024
s_and_b32 s57, s57, 0xffff
buffer_load_dwordx4 v10, s[16:19], s47 offen  lds
s_add_u32 m0, m0, 1024
s_nop 0
buffer_load_dwordx4 v11, s[16:19], s47 offen  lds
s_add_u32 m0, s51, s50
s_waitcnt vmcnt(15)
s_barrier
P1_w:
buffer_load_dwordx4 v13, s[20:23], s48 offen offset:0  lds
s_add_u32 m0, m0, 1024
s_add_u32 s52, s52, 1
buffer_load_dwordx4 v14, s[20:23], s48 offen offset:0  lds
s_add_u32 m0, m0, 896
s_add_u32 s51, s51, 28672
buffer_load_dwordx4 v13, s[20:23], s48 offen offset:128  lds
s_add_u32 m0, m0, 1024
v_readlane_b32 s47, v30, s52
buffer_load_dwordx4 v14, s[20:23], s48 offen offset:128  lds
s_add_u32 m0, m0, 896
s_cmp_eq_u32 s51, 86016
s_cselect_b32 s51, 0, s51
buffer_load_dwordx4 v13, s[20:23], s48 offen offset:256  lds
s_add_u32 m0, m0, 1024
s_nop 0
buffer_load_dwordx4 v14, s[20:23], s48 offen offset:256  lds
s_add_u32 m0, m0, 1280
s_cmp_lt_u32 s52, 16
buffer_load_dwordx4 v12, s[20:23], s48 offen  lds
s_cbranch_scc1 P1_loop
s_branch P1_done
P1_hk:
s_cmp_eq_u32 s52, 15
s_cbranch_scc0 P1_hk1
s_cmp_eq_u32 s46, 0
s_cbranch_scc0 P1_hkb
s_load_dwordx4 s[28:31], s[6:7], 0
s_branch P1_hkb
P1_hk1:
s_lshl_b32 s1, s43, 2
s_add_u32 s1, s1, s46
s_cmp_eq_u32 s1, 2
s_cbranch_scc0 P1_hkb
s_mov_b32 s1, 1
s_atomic_add s1, s[6:7], 0
s_branch P1_hkb
P1_done:
PAD0:
s_cbranch_execz PAD1
s_lshl_b32 s49, s46, 12
s_add_u32 s50, s49, 65536
s_mov_b32 s52, 0
s_mov_b32 s51, 0
v_readlane_b32 s47, v21, 0
s_waitcnt vmcnt(7)
s_barrier
s_waitcnt vmcnt(0)
s_barrier
s_branch P2_w0
P2_w:
s_add_u32 s52, s52, 1
s_add_u32 s51, s51, 16384
v_readlane_b32 s47, v21, s52
s_nop 2
P2_w0:
s_add_u32 m0, s50, s51
s_nop 0
buffer_load_dwordx4 v22, s[24:27], s47 offen offset:0  lds
s_add_u32 m0, m0, 896
s_nop 0
buffer_load_dwordx4 v22, s[24:27], s47 offen offset:128  lds
s_add_u32 m0, m0, 1152
s_nop 0
buffer_load_dwordx4 v23, s[24:27], s47 offen offset:0  lds
s_add_u32 m0, m0, 896
s_nop 0
buffer_load_dwordx4 v23, s[24:27], s47 offen offset:128  lds
s_cmp_lt_u32 s52, 2
s_cbranch_scc1 P2_w
s_barrier
PAD1:
s_cbranch_execz PAD2
P2_w2:
s_add_u32 s52, s52, 1
s_add_u32 s51, s51, 16384
v_readlane_b32 s47, v21, s52
s_nop 2
s_add_u32 m0, s50, s51
s_nop 0
buffer_load_dwordx4 v22, s[24:27], s47 offen offset:0  lds
s_add_u32 m0, m0, 896
s_nop 0
buffer_load_dwordx4 v22, s[24:27], s47 offen offset:128  lds
s_add_u32 m0, m0, 1152
s_nop 0
buffer_load_dwordx4 v23, s[24:27], s47 offen offset:0  lds
s_add_u32 m0, m0, 896
s_nop 0
buffer_load_dwordx4 v23, s[24:27], s47 offen offset:128  lds
s_cmp_lt_u32 s52, 3
s_cbranch_scc1 P2_w2
s_cmp_eq_u32 s46, 0
s_cbranch_scc0 P2_hsd
s_mov_b32 s58, 0
s_branch P2_hsw
P2_hs:
s_load_dwordx4 s[28:31], s[6:7], 0 glc
s_add_u32 s58, s58, 1
P2_hsw:
s_waitcnt lgkmcnt(0)
s_cmp_ge_u32 s58, 131072
s_cbranch_scc1 P2_hsd
s_cmp_eq_u32 s28, 0
s_cbranch_scc1 P2_hs
P2_hsd:
s_lshr_b32 s59, s44, 3
s_lshl_b32 s59, s59, 10
s_add_u32 s59, s59, 50332416
s_lshl_b32 s53, s42, 2
v_mov_b32 v5, 2147483632
v_mov_b32 v6, s53
v_cmp_eq_u32 vcc, 0, v2
v_and_b32 v3, 7, v2
v_lshlrev_b32 v3, 2, v3
v_cndmask_b32 v6, v5, v6, vcc
v_mov_b32 v5, 1
v_readlane_b32 s48, v20, 3
s_waitcnt vmcnt(12)
s_barrier
s_cmp_eq_u32 s46, 1
s_cbranch_scc0 P2_nf
buffer_store_dword v5, v6, s[36:39], s59 offen sc1
s_nop 1
v_mov_b32 v5, 7
P2_nf:
s_cmp_eq_u32 s46, 0
s_cbranch_scc1 P2_p0
s_waitcnt vmcnt(0)
s_branch P2_go
P2_p0:
s_mov_b32 s58, 0
P2_l1:
s_load_dwordx8 s[16:23], s[4:5], 0 glc
s_add_u32 s58, s58, 1
s_waitcnt lgkmcnt(0)
s_and_b64 s[16:17], s[16:17], s[18:19]
s_and_b64 s[20:21], s[20:21], s[22:23]
s_and_b64 s[16:17], s[16:17], s[20:21]
s_and_b32 s16, s16, s17
s_cmp_ge_u32 s58, 131072
s_cbranch_scc1 P2_rdy
s_bitcmp1_b32 s16, 0
s_cbranch_scc1 P2_rdy
s_branch P2_l1
P2_rdy:
s_mov_b32 m0, 49152
s_mov_b32 s58, 0
P2_h3:
buffer_load_dwordx4 v26, s[36:39], s48 offen sc1 lds
s_add_u32 m0, m0, 1024
s_nop 0
buffer_load_dwordx4 v27, s[36:39], s48 offen sc1 lds
s_add_u32 m0, m0, 1024
s_nop 0
buffer_load_dwordx4 v28, s[36:39], s48 offen sc1 lds
s_add_u32 m0, m0, 1024
s_nop 0
buffer_load_dwordx4 v29, s[36:39], s48 offen sc1 lds
s_add_u32 m0, m0, 1024
s_add_u32 s48, s48, 5120
s_add_u32 s58, s58, 1
s_cmp_lt_u32 s58, 4
s_cbranch_scc1 P2_h3
P2_go:
PAD2:
s_cbranch_execz PAD3
s_mov_b32 s52, 4
s_mov_b32 s57, 9455168
v_readlane_b32 s47, v21, 4
s_mov_b32 s51, 0
s_mov_b32 m0, s50
s_branch P2_bar
.p2align 3
P2_loop:
s_bitcmp1_b32 s57, s52
s_cbranch_scc1 P2_hk
P2_hkb:
s_add_u32 m0, s49, s51
s_add_u32 s52, s52, 1
buffer_load_dwordx4 v26, s[36:39], s48 offen sc1 lds
s_add_u32 m0, m0, 1024
v_readlane_b32 s47, v21, s52
buffer_load_dwordx4 v27, s[36:39], s48 offen sc1 lds
s_add_u32 m0, m0, 1024
s_add_u32 s51, s51, 16384
buffer_load_dwordx4 v28, s[36:39], s48 offen sc1 lds
s_add_u32 m0, m0, 1024
s_and_b32 s51, s51, 0xffff
buffer_load_dwordx4 v29, s[36:39], s48 offen sc1 lds
s_add_u32 m0, s50, s51
P2_bar:
s_waitcnt vmcnt(16)
s_barrier
s_cmp_lt_u32 s52, 24
s_cbranch_scc0 P2_out
buffer_load_dwordx4 v22, s[24:27], s47 offen offset:0  lds
s_add_u32 m0, m0, 896
v_readlane_b32 s48, v20, s52
buffer_load_dwordx4 v22, s[24:27], s47 offen offset:128  lds
s_add_u32 m0, m0, 1152
s_nop 0
buffer_load_dwordx4 v23, s[24:27], s47 offen offset:0  lds
s_add_u32 m0, m0, 896
s_nop 0
buffer_load_dwordx4 v23, s[24:27], s47 offen offset:128  lds
s_branch P2_loop
P2_hk:
PAD3:
s_cbranch_execz PAD4
s_cmp_eq_u32 s52, 23
s_cbranch_scc0 P2_hk1
v_mov_b32 v22, v24
v_mov_b32 v23, v25
s_branch P2_hkb
P2_hk1:
s_cmp_lt_u32 s52, 14
s_cbranch_scc1 P2_hk1a
s_cmp_eq_u32 s46, 0
s_cbranch_scc0 P2_hkb
s_mov_b32 s58, 0
s_cmp_eq_u32 s52, 20
s_cbranch_scc1 P2_pw
s_xor_b32 s4, s4, 1024
s_xor_b32 s53, s42, 0
s_lshl_b32 s53, s53, 2
s_add_u32 s4, s4, s53
s_load_dword s28, s[4:5], 0 glc
s_branch P2_hkb
P2_pl:
s_load_dword s28, s[4:5], 0 glc
s_add_u32 s58, s58, 1
P2_pw:
s_waitcnt lgkmcnt(0)
s_cmp_ge_u32 s58, 131072
s_cbranch_scc1 P2_hkb
s_cmp_eq_u32 s28, 0
s_cbranch_scc1 P2_pl
s_branch P2_hkb
P2_hk1a:
s_cmp_eq_u32 s52, 9
s_cbranch_scc0 P2_hk2
buffer_load_dword v4, v3, s[36:39], s59 offen sc1
s_branch P2_hkb
P2_hk2:
s_cmp_eq_u32 s52, 10
s_cbranch_scc1 P2_hk3
s_cmp_eq_u32 s46, 1
s_cbranch_scc0 P2_hkb
buffer_store_dword v5, v6, s[36:39], s59 offen sc1
s_branch P2_hkb
P2_hk3:
s_waitcnt vmcnt(8)
v_cmp_gt_u32 vcc, 7, v4
s_mov_b32 s58, 0
s_nop 3
s_cbranch_vccz P2_hkb
P2_l2:
buffer_load_dword v4, v3, s[36:39], s59 offen sc1
s_add_u32 s58, s58, 1
s_waitcnt vmcnt(0)
v_cmp_gt_u32 vcc, 7, v4
s_cmp_lt_u32 s58, 131072
s_cselect_b64 s[60:61], -1, 0
s_and_b64 vcc, vcc, s[60:61]
s_cbranch_scc1 P2_l2
s_branch P2_hkb
P2_out:
s_lshl_b32 s11, s41, 7
s_xor_b32 s10, s11, 128
s_lshl_b32 s9, s41, 10
s_xor_b32 s8, s9, 1024
s_add_u32 s8, s8, s50
s_add_u32 s9, s9, s50
v_readlane_b32 s48, v20, 24
v_readlane_b32 s47, v21, 24
s_add_u32 m0, s8, 0
s_nop 2
s_add_u32 s47, s47, s10
buffer_load_dwordx4 v22, s[24:27], s47 offen  lds
s_add_u32 m0, m0, 2048
s_nop 0
buffer_load_dwordx4 v23, s[24:27], s47 offen  lds
s_add_u32 m0, s49, 0
s_nop 0
buffer_load_dwordx4 v26, s[36:39], s48 offen sc1 lds
s_add_u32 m0, m0, 1024
s_nop 0
buffer_load_dwordx4 v27, s[36:39], s48 offen sc1 lds
s_add_u32 m0, m0, 1024
s_nop 0
buffer_load_dwordx4 v28, s[36:39], s48 offen sc1 lds
s_add_u32 m0, m0, 1024
s_nop 0
buffer_load_dwordx4 v29, s[36:39], s48 offen sc1 lds
s_waitcnt vmcnt(14)
s_barrier
v_readlane_b32 s48, v20, 25
v_readlane_b32 s47, v21, 25
s_add_u32 m0, s8, 16384
s_nop 2
s_add_u32 s47, s47, s10
buffer_load_dwordx4 v22, s[24:27], s47 offen  lds
s_add_u32 m0, m0, 2048
s_nop 0
buffer_load_dwordx4 v23, s[24:27], s47 offen  lds
s_add_u32 m0, s49, 16384
s_nop 0
buffer_load_dwordx4 v26, s[36:39], s48 offen sc1 lds
s_add_u32 m0, m0, 1024
s_nop 0
buffer_load_dwordx4 v27, s[36:39], s48 offen sc1 lds
s_add_u32 m0, m0, 1024
s_nop 0
buffer_load_dwordx4 v28, s[36:39], s48 offen sc1 lds
s_add_u32 m0, m0, 1024
s_nop 0
buffer_load_dwordx4 v29, s[36:39], s48 offen sc1 lds
PAD4:
s_cbranch_execz PAD5
s_waitcnt vmcnt(12)
s_barrier
v_readlane_b32 s48, v20, 26
v_readlane_b32 s47, v21, 26
s_add_u32 m0, s8, 32768
s_nop 2
s_add_u32 s47, s47, s10
buffer_load_dwordx4 v22, s[24:27], s47 offen  lds
s_add_u32 m0, m0, 2048
s_nop 0
buffer_load_dwordx4 v23, s[24:27], s47 offen  lds
s_add_u32 m0, s49, 32768
s_nop 0
buffer_load_dwordx4 v26, s[36:39], s48 offen sc1 lds
s_add_u32 m0, m0, 1024
s_nop 0
buffer_load_dwordx4 v27, s[36:39], s48 offen sc1 lds
s_add_u32 m0, m0, 1024
s_nop 0
buffer_load_dwordx4 v28, s[36:39], s48 offen sc1 lds
s_add_u32 m0, m0, 1024
s_nop 0
buffer_load_dwordx4 v29, s[36:39], s48 offen sc1 lds
s_waitcnt vmcnt(12)
s_barrier
v_readlane_b32 s48, v20, 27
v_readlane_b32 s47, v21, 27
s_add_u32 m0, s8, 49152
s_nop 2
s_add_u32 s47, s47, s10
buffer_load_dwordx4 v22, s[24:27], s47 offen  lds
s_add_u32 m0, m0, 2048
s_nop 0
buffer_load_dwordx4 v23, s[24:27], s47 offen  lds
s_add_u32 m0, s49, 49152
s_nop 0
buffer_load_dwordx4 v26, s[36:39], s48 offen sc1 lds
s_add_u32 m0, m0, 1024
s_nop 0
buffer_load_dwordx4 v27, s[36:39], s48 offen sc1 lds
s_add_u32 m0, m0, 1024
s_nop 0
buffer_load_dwordx4 v28, s[36:39], s48 offen sc1 lds
s_add_u32 m0, m0, 1024
s_nop 0
buffer_load_dwordx4 v29, s[36:39], s48 offen sc1 lds
s_waitcnt vmcnt(12)
s_barrier
v_readlane_b32 s47, v21, 24
s_add_u32 m0, s9, 0
s_nop 2
s_add_u32 s47, s47, s11
buffer_load_dwordx4 v22, s[24:27], s47 offen  lds
s_add_u32 m0, m0, 2048
s_nop 0
buffer_load_dwordx4 v23, s[24:27], s47 offen  lds
v_readlane_b32 s47, v21, 25
s_add_u32 m0, s9, 16384
s_nop 2
s_add_u32 s47, s47, s11
buffer_load_dwordx4 v22, s[24:27], s47 offen  lds
s_add_u32 m0, m0, 2048
s_nop 0
buffer_load_dwordx4 v23, s[24:27], s47 offen  lds
s_waitcnt vmcnt(10)
s_barrier
v_readlane_b32 s47, v21, 26
s_add_u32 m0, s9, 32768
s_nop 2
s_add_u32 s47, s47, s11
buffer_load_dwordx4 v22, s[24:27], s47 offen  lds
s_add_u32 m0, m0, 2048
s_nop 0
buffer_load_dwordx4 v23, s[24:27], s47 offen  lds
v_readlane_b32 s47, v21, 27
s_add_u32 m0, s9, 49152
s_nop 2
s_add_u32 s47, s47, s11
buffer_load_dwordx4 v22, s[24:27], s47 offen  lds
s_add_u32 m0, m0, 2048
s_nop 0
buffer_load_dwordx4 v23, s[24:27], s47 offen  lds
s_waitcnt vmcnt(8)
s_barrier
s_waitcnt vmcnt(6)
s_barrier
s_waitcnt vmcnt(0)
s_barrier
s_endpgm
.p2align 6
L_cons:
s_waitcnt lgkmcnt(0)
s_mov_b32 s16, s4
s_and_b32 s17, s5, 0xffff
s_mov_b32 s18, 4194304
s_mov_b32 s19, 0x20000
s_setprio 1
s_lshr_b32 s46, s3, 1
s_and_b32 s47, s3, 1
v_and_b32 v3, 15, v2
v_lshrrev_b32 v12, 4, v2
v_lshrrev_b32 v13, 1, v3
v_xor_b32 v13, v13, v12
v_lshlrev_b32 v13, 4, v13
s_lshl_b32 s58, s46, 13
v_lshlrev_b32 v14, 7, v3
v_add3_u32 v9, v13, v14, s58
v_lshrrev_b32 v13, 1, v12
v_mul_u32_u24 v13, 7168, v13
v_bfe_u32 v15, v2, 2, 2
v_lshl_add_u32 v13, v15, 6, v13
v_and_b32 v15, 3, v2
v_lshl_add_u32 v13, v15, 3, v13
v_and_b32 v14, 1, v12
v_mul_u32_u24 v15, 1056, v14
s_lshl_b32 s58, s47, 9
s_add_u32 s58, s58, 65536
v_add3_u32 v10, v13, v15, s58
v_mul_u32_u24 v15, 544, v14
v_add_u32 v13, v13, v15
s_lshl_b32 s58, s47, 5
v_xor_b32 v13, s58, v13
v_add_u32 v11, 71680, v13
v_and_b32 v6, 7, v2
v_lshlrev_b32 v6, 4, v6
v_lshrrev_b32 v5, 3, v2
v_add_u32 v5, 0, v5
v_add_u32 v4, 4, v5
v_mul_u32_u24 v4, 37, v4
v_lshrrev_b32 v4, 8, v4
v_add_u32 v4, v4, v5
v_lshlrev_b32 v248, 7, v4
v_add_u32 v248, v248, v6
v_lshrrev_b32 v5, 3, v2
v_add_u32 v5, 8, v5
v_add_u32 v4, 4, v5
v_mul_u32_u24 v4, 37, v4
v_lshrrev_b32 v4, 8, v4
v_add_u32 v4, v4, v5
v_lshlrev_b32 v249, 7, v4
v_add_u32 v249, v249, v6
v_lshrrev_b32 v5, 3, v2
v_add_u32 v5, 16, v5
v_add_u32 v4, 4, v5
v_mul_u32_u24 v4, 37, v4
v_lshrrev_b32 v4, 8, v4
v_add_u32 v4, v4, v5
v_lshlrev_b32 v250, 7, v4
v_add_u32 v250, v250, v6
v_lshrrev_b32 v5, 3, v2
v_add_u32 v5, 24, v5
v_add_u32 v4, 4, v5
v_mul_u32_u24 v4, 37, v4
v_lshrrev_b32 v4, 8, v4
v_add_u32 v4, v4, v5
v_lshlrev_b32 v251, 7, v4
v_add_u32 v251, v251, v6
v_add_u32 v6, 57344, v10
v_mov_b32 v4, v9
v_add_u32 v8, 57344, v11
v_xor_b32 v7, 32, v6
v_xor_b32 v5, 64, v4
s_mov_b32 s28, s10
s_and_b32 s29, s11, 0xffff
s_mov_b32 s30, 4194304
s_mov_b32 s31, 0x20000
s_mov_b32 s36, s14
s_and_b32 s37, s15, 0xffff
s_mov_b32 s38, 268435456
s_mov_b32 s39, 0x20000
s_mov_b32 s24, s8
s_and_b32 s25, s9, 0xffff
s_mov_b32 s26, 7340032
s_mov_b32 s27, 0x20000
v_lshlrev_b32 v3, 4, v2
s_lshr_b32 s56, s44, 3
s_lshl_b32 s56, s56, 10
s_lshl_b32 s7, s42, 2
s_add_u32 s56, s56, s7
s_add_u32 s56, s56, 50332416
s_cmp_eq_u32 s43, 0
s_cselect_b32 s7, 16, 0
v_lshrrev_b32 v13, 3, v2
v_lshlrev_b32 v13, 10, v13
v_and_b32 v1, 7, v2
v_lshl_add_u32 v13, v1, 2, v13
v_mov_b32 v1, 2147483632
v_cmp_gt_u32 vcc, s7, v2
s_nop 1
v_cndmask_b32 v1, v1, v13, vcc
s_andn2_b32 s57, s44, 7
s_add_u32 s57, s57, s63
s_lshl_b32 s57, s57, 2
s_add_u32 s57, s57, s3
s_mul_i32 s57, s57, 5120
s_add_u32 s57, s57, 25165824
v_mov_b32 v233, 2147483632
v_mov_b32 v234, 2147483632
v_mov_b32 v244, -1
v_mov_b32 v245, -1
v_mov_b32 v246, -1
v_mov_b32 v247, -1
s_mov_b32 s48, 0
s_mov_b32 s49, 57344
s_mov_b32 s4, 0
s_cmp_eq_u32 s43, 0
s_cselect_b32 s0, 4, -1
v_mov_b32 v13, 0
buffer_store_dword v13, v1, s[36:39], s56 offen sc1
s_barrier
ds_read_b64_tr_b16 v[144:145], v6 offset:0
ds_read_b64_tr_b16 v[146:147], v6 offset:256
ds_read_b128 v[128:131], v4 offset:0
ds_read_b128 v[132:135], v4 offset:2048
ds_read_b128 v[136:139], v4 offset:4096
ds_read_b128 v[140:143], v4 offset:6144
ds_read_b64_tr_b16 v[148:149], v7 offset:0
ds_read_b64_tr_b16 v[150:151], v7 offset:256
ds_read_b64_tr_b16 v[152:153], v6 offset:2048
ds_read_b64_tr_b16 v[154:155], v6 offset:2304
ds_read_b64_tr_b16 v[156:157], v7 offset:2048
ds_read_b64_tr_b16 v[158:159], v7 offset:2304
ds_read_b64_tr_b16 v[160:161], v6 offset:4096
ds_read_b64_tr_b16 v[162:163], v6 offset:4352
ds_read_b64_tr_b16 v[164:165], v7 offset:4096
ds_read_b64_tr_b16 v[166:167], v7 offset:4352
ds_read_b64_tr_b16 v[168:169], v8 offset:0
ds_read_b64_tr_b16 v[170:171], v8 offset:256
s_waitcnt lgkmcnt(0)
v_mfma_f32_16x16x32_bf16 v[16:19], v[144:147], v[128:131], 0
ds_read_b64_tr_b16 v[188:189], v6 offset:14336
v_mfma_f32_16x16x32_bf16 v[20:23], v[144:147], v[132:135], 0
ds_read_b64_tr_b16 v[190:191], v6 offset:14592
v_mfma_f32_16x16x32_bf16 v[24:27], v[144:147], v[136:139], 0
ds_read_b128 v[172:175], v5 offset:0
v_mfma_f32_16x16x32_bf16 v[28:31], v[144:147], v[140:143], 0
ds_read_b128 v[176:179], v5 offset:2048
v_mfma_f32_16x16x32_bf16 v[44:47], v[148:151], v[140:143], 0
ds_read_b128 v[180:183], v5 offset:4096
v_mfma_f32_16x16x32_bf16 v[40:43], v[148:151], v[136:139], 0
ds_read_b128 v[184:187], v5 offset:6144
v_mfma_f32_16x16x32_bf16 v[36:39], v[148:151], v[132:135], 0
ds_read_b64_tr_b16 v[192:193], v7 offset:14336
v_mfma_f32_16x16x32_bf16 v[32:35], v[148:151], v[128:131], 0
ds_read_b64_tr_b16 v[194:195], v7 offset:14592
v_mfma_f32_16x16x32_bf16 v[48:51], v[152:155], v[128:131], 0
ds_read_b64_tr_b16 v[196:197], v6 offset:16384
v_mfma_f32_16x16x32_bf16 v[52:55], v[152:155], v[132:135], 0
ds_read_b64_tr_b16 v[198:199], v6 offset:16640
v_mfma_f32_16x16x32_bf16 v[56:59], v[152:155], v[136:139], 0
ds_read_b64_tr_b16 v[200:201], v7 offset:16384
v_mfma_f32_16x16x32_bf16 v[60:63], v[152:155], v[140:143], 0
ds_read_b64_tr_b16 v[202:203], v7 offset:16640
v_mfma_f32_16x16x32_bf16 v[76:79], v[156:159], v[140:143], 0
ds_read_b64_tr_b16 v[204:205], v6 offset:18432
v_mfma_f32_16x16x32_bf16 v[72:75], v[156:159], v[136:139], 0
ds_read_b64_tr_b16 v[206:207], v6 offset:18688
v_mfma_f32_16x16x32_bf16 v[68:71], v[156:159], v[132:135], 0
ds_read_b64_tr_b16 v[208:209], v7 offset:18432
v_mfma_f32_16x16x32_bf16 v[64:67], v[156:159], v[128:131], 0
ds_read_b64_tr_b16 v[210:211], v7 offset:18688
v_mfma_f32_16x16x32_bf16 v[80:83], v[160:163], v[128:131], 0
ds_read_b64_tr_b16 v[212:213], v8 offset:14336
v_mfma_f32_16x16x32_bf16 v[84:87], v[160:163], v[132:135], 0
ds_read_b64_tr_b16 v[214:215], v8 offset:14592
v_mfma_f32_16x16x32_bf16 v[88:91], v[160:163], v[136:139], 0
s_add_u32 s49, s49, 28672
s_add_u32 s4, s4, 16384
v_mfma_f32_16x16x32_bf16 v[92:95], v[160:163], v[140:143], 0
s_cmp_eq_u32 s49, 86016
s_cselect_b32 s49, 0, s49
v_mfma_f32_16x16x32_bf16 v[108:111], v[164:167], v[140:143], 0
v_add_u32 v6, s49, v10
s_and_b32 s4, s4, 0xffff
v_mfma_f32_16x16x32_bf16 v[104:107], v[164:167], v[136:139], 0
v_add_u32 v4, s4, v9
v_mfma_f32_16x16x32_bf16 v[100:103], v[164:167], v[132:135], 0
v_add_u32 v8, s49, v11
v_mfma_f32_16x16x32_bf16 v[96:99], v[164:167], v[128:131], 0
v_xor_b32 v7, 32, v6
v_mfma_f32_16x16x32_bf16 v[112:115], v[168:171], v[128:131], 0
v_xor_b32 v5, 64, v4
v_mfma_f32_16x16x32_bf16 v[116:119], v[168:171], v[132:135], 0
v_mfma_f32_16x16x32_bf16 v[120:123], v[168:171], v[136:139], 0
v_mfma_f32_16x16x32_bf16 v[124:127], v[168:171], v[140:143], 0
s_branch C1_in
.p2align 3
C1_loop:
v_mfma_f32_16x16x32_bf16 v[16:19], v[144:147], v[128:131], v[16:19]
ds_read_b64_tr_b16 v[188:189], v6 offset:14336
v_mfma_f32_16x16x32_bf16 v[20:23], v[144:147], v[132:135], v[20:23]
ds_read_b64_tr_b16 v[190:191], v6 offset:14592
v_mfma_f32_16x16x32_bf16 v[24:27], v[144:147], v[136:139], v[24:27]
ds_read_b128 v[172:175], v5 offset:0
v_mfma_f32_16x16x32_bf16 v[28:31], v[144:147], v[140:143], v[28:31]
ds_read_b128 v[176:179], v5 offset:2048
v_mfma_f32_16x16x32_bf16 v[44:47], v[148:151], v[140:143], v[44:47]
ds_read_b128 v[180:183], v5 offset:4096
v_mfma_f32_16x16x32_bf16 v[40:43], v[148:151], v[136:139], v[40:43]
ds_read_b128 v[184:187], v5 offset:6144
v_mfma_f32_16x16x32_bf16 v[36:39], v[148:151], v[132:135], v[36:39]
ds_read_b64_tr_b16 v[192:193], v7 offset:14336
v_mfma_f32_16x16x32_bf16 v[32:35], v[148:151], v[128:131], v[32:35]
ds_read_b64_tr_b16 v[194:195], v7 offset:14592
v_mfma_f32_16x16x32_bf16 v[48:51], v[152:155], v[128:131], v[48:51]
ds_read_b64_tr_b16 v[196:197], v6 offset:16384
v_mfma_f32_16x16x32_bf16 v[52:55], v[152:155], v[132:135], v[52:55]
ds_read_b64_tr_b16 v[198:199], v6 offset:16640
v_mfma_f32_16x16x32_bf16 v[56:59], v[152:155], v[136:139], v[56:59]
ds_read_b64_tr_b16 v[200:201], v7 offset:16384
v_mfma_f32_16x16x32_bf16 v[60:63], v[152:155], v[140:143], v[60:63]
ds_read_b64_tr_b16 v[202:203], v7 offset:16640
v_mfma_f32_16x16x32_bf16 v[76:79], v[156:159], v[140:143], v[76:79]
ds_read_b64_tr_b16 v[204:205], v6 offset:18432
v_mfma_f32_16x16x32_bf16 v[72:75], v[156:159], v[136:139], v[72:75]
ds_read_b64_tr_b16 v[206:207], v6 offset:18688
v_mfma_f32_16x16x32_bf16 v[68:71], v[156:159], v[132:135], v[68:71]
ds_read_b64_tr_b16 v[208:209], v7 offset:18432
v_mfma_f32_16x16x32_bf16 v[64:67], v[156:159], v[128:131], v[64:67]
ds_read_b64_tr_b16 v[210:211], v7 offset:18688
v_mfma_f32_16x16x32_bf16 v[80:83], v[160:163], v[128:131], v[80:83]
ds_read_b64_tr_b16 v[212:213], v8 offset:14336
v_mfma_f32_16x16x32_bf16 v[84:87], v[160:163], v[132:135], v[84:87]
ds_read_b64_tr_b16 v[214:215], v8 offset:14592
v_mfma_f32_16x16x32_bf16 v[88:91], v[160:163], v[136:139], v[88:91]
s_add_u32 s49, s49, 28672
s_add_u32 s4, s4, 16384
v_mfma_f32_16x16x32_bf16 v[92:95], v[160:163], v[140:143], v[92:95]
s_cmp_eq_u32 s49, 86016
s_cselect_b32 s49, 0, s49
v_mfma_f32_16x16x32_bf16 v[108:111], v[164:167], v[140:143], v[108:111]
v_add_u32 v6, s49, v10
s_and_b32 s4, s4, 0xffff
v_mfma_f32_16x16x32_bf16 v[104:107], v[164:167], v[136:139], v[104:107]
v_add_u32 v4, s4, v9
v_mfma_f32_16x16x32_bf16 v[100:103], v[164:167], v[132:135], v[100:103]
v_add_u32 v8, s49, v11
v_mfma_f32_16x16x32_bf16 v[96:99], v[164:167], v[128:131], v[96:99]
v_xor_b32 v7, 32, v6
v_mfma_f32_16x16x32_bf16 v[112:115], v[168:171], v[128:131], v[112:115]
v_xor_b32 v5, 64, v4
v_mfma_f32_16x16x32_bf16 v[116:119], v[168:171], v[132:135], v[116:119]
s_cmp_eq_u32 s48, 1
v_mfma_f32_16x16x32_bf16 v[120:123], v[168:171], v[136:139], v[120:123]
s_cbranch_scc1 H1_clr
H1_clr_b:
v_mfma_f32_16x16x32_bf16 v[124:127], v[168:171], v[140:143], v[124:127]
C1_in:
s_waitcnt lgkmcnt(0)
s_barrier
v_mfma_f32_16x16x32_bf16 v[16:19], v[188:191], v[172:175], v[16:19]
ds_read_b64_tr_b16 v[144:145], v6 offset:0
v_mfma_f32_16x16x32_bf16 v[20:23], v[188:191], v[176:179], v[20:23]
ds_read_b64_tr_b16 v[146:147], v6 offset:256
v_mfma_f32_16x16x32_bf16 v[24:27], v[188:191], v[180:183], v[24:27]
ds_read_b128 v[128:131], v4 offset:0
v_mfma_f32_16x16x32_bf16 v[28:31], v[188:191], v[184:187], v[28:31]
ds_read_b128 v[132:135], v4 offset:2048
v_mfma_f32_16x16x32_bf16 v[44:47], v[192:195], v[184:187], v[44:47]
ds_read_b128 v[136:139], v4 offset:4096
v_mfma_f32_16x16x32_bf16 v[40:43], v[192:195], v[180:183], v[40:43]
ds_read_b128 v[140:143], v4 offset:6144
v_mfma_f32_16x16x32_bf16 v[36:39], v[192:195], v[176:179], v[36:39]
ds_read_b64_tr_b16 v[148:149], v7 offset:0
v_mfma_f32_16x16x32_bf16 v[32:35], v[192:195], v[172:175], v[32:35]
ds_read_b64_tr_b16 v[150:151], v7 offset:256
v_mfma_f32_16x16x32_bf16 v[48:51], v[196:199], v[172:175], v[48:51]
ds_read_b64_tr_b16 v[152:153], v6 offset:2048
v_mfma_f32_16x16x32_bf16 v[52:55], v[196:199], v[176:179], v[52:55]
ds_read_b64_tr_b16 v[154:155], v6 offset:2304
v_mfma_f32_16x16x32_bf16 v[56:59], v[196:199], v[180:183], v[56:59]
ds_read_b64_tr_b16 v[156:157], v7 offset:2048
v_mfma_f32_16x16x32_bf16 v[60:63], v[196:199], v[184:187], v[60:63]
ds_read_b64_tr_b16 v[158:159], v7 offset:2304
v_mfma_f32_16x16x32_bf16 v[76:79], v[200:203], v[184:187], v[76:79]
ds_read_b64_tr_b16 v[160:161], v6 offset:4096
v_mfma_f32_16x16x32_bf16 v[72:75], v[200:203], v[180:183], v[72:75]
ds_read_b64_tr_b16 v[162:163], v6 offset:4352
v_mfma_f32_16x16x32_bf16 v[68:71], v[200:203], v[176:179], v[68:71]
ds_read_b64_tr_b16 v[164:165], v7 offset:4096
v_mfma_f32_16x16x32_bf16 v[64:67], v[200:203], v[172:175], v[64:67]
ds_read_b64_tr_b16 v[166:167], v7 offset:4352
v_mfma_f32_16x16x32_bf16 v[80:83], v[204:207], v[172:175], v[80:83]
ds_read_b64_tr_b16 v[168:169], v8 offset:0
v_mfma_f32_16x16x32_bf16 v[84:87], v[204:207], v[176:179], v[84:87]
ds_read_b64_tr_b16 v[170:171], v8 offset:256
v_mfma_f32_16x16x32_bf16 v[88:91], v[204:207], v[180:183], v[88:91]
s_cmp_eq_u32 s48, s0
v_mfma_f32_16x16x32_bf16 v[92:95], v[204:207], v[184:187], v[92:95]
s_cbranch_scc1 H1_ack
H1_ack_b:
v_mfma_f32_16x16x32_bf16 v[108:111], v[208:211], v[184:187], v[108:111]
s_cmp_eq_u32 s48, 1
v_mfma_f32_16x16x32_bf16 v[104:107], v[208:211], v[180:183], v[104:107]
s_cbranch_scc1 H1_late
H1_late_b:
v_mfma_f32_16x16x32_bf16 v[100:103], v[208:211], v[176:179], v[100:103]
s_cmp_eq_u32 s48, 2
v_mfma_f32_16x16x32_bf16 v[96:99], v[208:211], v[172:175], v[96:99]
s_cbranch_scc1 H1_pf1
H1_pf1_b:
v_mfma_f32_16x16x32_bf16 v[112:115], v[212:215], v[172:175], v[112:115]
s_cmp_eq_u32 s48, 12
v_mfma_f32_16x16x32_bf16 v[116:119], v[212:215], v[176:179], v[116:119]
s_cbranch_scc1 H1_pf
H1_pf_b:
v_mfma_f32_16x16x32_bf16 v[120:123], v[212:215], v[180:183], v[120:123]
PAD5:
s_cbranch_execz PAD6
v_mfma_f32_16x16x32_bf16 v[124:127], v[212:215], v[184:187], v[124:127]
s_add_u32 s48, s48, 1
s_cmp_lt_u32 s48, 16
s_waitcnt lgkmcnt(0)
s_cbranch_scc1 C1_loop
PAD6:
s_cbranch_execz C_wret
v_pk_mul_f32 v[216:217], s[52:53], v[16:17]
v_pk_mul_f32 v[218:219], s[52:53], v[18:19]
v_pk_mul_f32 v[220:221], s[52:53], v[32:33]
v_pk_mul_f32 v[222:223], s[52:53], v[34:35]
v_exp_f32 v216, v216
v_exp_f32 v217, v217
v_exp_f32 v218, v218
v_exp_f32 v219, v219
v_exp_f32 v220, v220
v_exp_f32 v221, v221
v_exp_f32 v222, v222
v_exp_f32 v223, v223
v_pk_add_f32 v[216:217], s[54:55], v[216:217]
v_pk_add_f32 v[218:219], s[54:55], v[218:219]
v_pk_add_f32 v[220:221], s[54:55], v[220:221]
v_pk_add_f32 v[222:223], s[54:55], v[222:223]
v_rcp_f32 v216, v216
v_rcp_f32 v217, v217
v_rcp_f32 v218, v218
v_rcp_f32 v219, v219
v_rcp_f32 v220, v220
v_rcp_f32 v221, v221
v_rcp_f32 v222, v222
v_rcp_f32 v223, v223
v_pk_mul_f32 v[216:217], v[216:217], v[16:17]
v_pk_mul_f32 v[218:219], v[218:219], v[18:19]
v_pk_mul_f32 v[220:221], v[220:221], v[32:33]
v_pk_mul_f32 v[222:223], v[222:223], v[34:35]
v_cvt_pk_bf16_f32 v160, v216, v217
v_cvt_pk_bf16_f32 v161, v218, v219
v_cvt_pk_bf16_f32 v162, v220, v221
v_cvt_pk_bf16_f32 v163, v222, v223
buffer_store_dwordx4 v[160:163], v248, s[36:39], s50 offen sc1
ds_write_b128 v232, v[160:163] offset:0
v_pk_mul_f32 v[216:217], s[52:53], v[20:21]
v_pk_mul_f32 v[218:219], s[52:53], v[22:23]
v_pk_mul_f32 v[220:221], s[52:53], v[36:37]
v_pk_mul_f32 v[222:223], s[52:53], v[38:39]
v_exp_f32 v216, v216
v_exp_f32 v217, v217
v_exp_f32 v218, v218
v_exp_f32 v219, v219
v_exp_f32 v220, v220
v_exp_f32 v221, v221
v_exp_f32 v222, v222
v_exp_f32 v223, v223
v_pk_add_f32 v[216:217], s[54:55], v[216:217]
v_pk_add_f32 v[218:219], s[54:55], v[218:219]
v_pk_add_f32 v[220:221], s[54:55], v[220:221]
v_pk_add_f32 v[222:223], s[54:55], v[222:223]
v_rcp_f32 v216, v216
v_rcp_f32 v217, v217
v_rcp_f32 v218, v218
v_rcp_f32 v219, v219
v_rcp_f32 v220, v220
v_rcp_f32 v221, v221
v_rcp_f32 v222, v222
v_rcp_f32 v223, v223
v_pk_mul_f32 v[216:217], v[216:217], v[20:21]
v_pk_mul_f32 v[218:219], v[218:219], v[22:23]
v_pk_mul_f32 v[220:221], v[220:221], v[36:37]
v_pk_mul_f32 v[222:223], v[222:223], v[38:39]
v_cvt_pk_bf16_f32 v164, v216, v217
v_cvt_pk_bf16_f32 v165, v218, v219
v_cvt_pk_bf16_f32 v166, v220, v221
v_cvt_pk_bf16_f32 v167, v222, v223
buffer_store_dwordx4 v[164:167], v249, s[36:39], s50 offen sc1
ds_write_b128 v232, v[164:167] offset:1024
PAD7:
s_cbranch_execz PAD8
v_pk_mul_f32 v[216:217], s[52:53], v[24:25]
v_pk_mul_f32 v[218:219], s[52:53], v[26:27]
v_pk_mul_f32 v[220:221], s[52:53], v[40:41]
v_pk_mul_f32 v[222:223], s[52:53], v[42:43]
v_exp_f32 v216, v216
v_exp_f32 v217, v217
v_exp_f32 v218, v218
v_exp_f32 v219, v219
v_exp_f32 v220, v220
v_exp_f32 v221, v221
v_exp_f32 v222, v222
v_exp_f32 v223, v223
v_pk_add_f32 v[216:217], s[54:55], v[216:217]
v_pk_add_f32 v[218:219], s[54:55], v[218:219]
v_pk_add_f32 v[220:221], s[54:55], v[220:221]
v_pk_add_f32 v[222:223], s[54:55], v[222:223]
v_rcp_f32 v216, v216
v_rcp_f32 v217, v217
v_rcp_f32 v218, v218
v_rcp_f32 v219, v219
v_rcp_f32 v220, v220
v_rcp_f32 v221, v221
v_rcp_f32 v222, v222
v_rcp_f32 v223, v223
v_pk_mul_f32 v[216:217], v[216:217], v[24:25]
v_pk_mul_f32 v[218:219], v[218:219], v[26:27]
v_pk_mul_f32 v[220:221], v[220:221], v[40:41]
v_pk_mul_f32 v[222:223], v[222:223], v[42:43]
v_cvt_pk_bf16_f32 v168, v216, v217
v_cvt_pk_bf16_f32 v169, v218, v219
v_cvt_pk_bf16_f32 v170, v220, v221
v_cvt_pk_bf16_f32 v171, v222, v223
buffer_store_dwordx4 v[168:171], v250, s[36:39], s50 offen sc1
ds_write_b128 v232, v[168:171] offset:2048
v_pk_mul_f32 v[216:217], s[52:53], v[28:29]
v_pk_mul_f32 v[218:219], s[52:53], v[30:31]
v_pk_mul_f32 v[220:221], s[52:53], v[44:45]
v_pk_mul_f32 v[222:223], s[52:53], v[46:47]
v_exp_f32 v216, v216
v_exp_f32 v217, v217
v_exp_f32 v218, v218
v_exp_f32 v219, v219
v_exp_f32 v220, v220
v_exp_f32 v221, v221
v_exp_f32 v222, v222
v_exp_f32 v223, v223
v_pk_add_f32 v[216:217], s[54:55], v[216:217]
v_pk_add_f32 v[218:219], s[54:55], v[218:219]
v_pk_add_f32 v[220:221], s[54:55], v[220:221]
v_pk_add_f32 v[222:223], s[54:55], v[222:223]
v_rcp_f32 v216, v216
v_rcp_f32 v217, v217
v_rcp_f32 v218, v218
v_rcp_f32 v219, v219
v_rcp_f32 v220, v220
v_rcp_f32 v221, v221
v_rcp_f32 v222, v222
v_rcp_f32 v223, v223
v_pk_mul_f32 v[216:217], v[216:217], v[28:29]
v_pk_mul_f32 v[218:219], v[218:219], v[30:31]
v_pk_mul_f32 v[220:221], v[220:221], v[44:45]
v_pk_mul_f32 v[222:223], v[222:223], v[46:47]
v_cvt_pk_bf16_f32 v172, v216, v217
v_cvt_pk_bf16_f32 v173, v218, v219
v_cvt_pk_bf16_f32 v174, v220, v221
v_cvt_pk_bf16_f32 v175, v222, v223
buffer_store_dwordx4 v[172:175], v251, s[36:39], s50 offen sc1
ds_write_b128 v232, v[172:175] offset:3072
s_add_u32 s50, s50, 20480
PAD8:
s_cbranch_execz PAD9
v_pk_mul_f32 v[216:217], s[52:53], v[48:49]
v_pk_mul_f32 v[218:219], s[52:53], v[50:51]
v_pk_mul_f32 v[220:221], s[52:53], v[64:65]
v_pk_mul_f32 v[222:223], s[52:53], v[66:67]
v_exp_f32 v216, v216
v_exp_f32 v217, v217
v_exp_f32 v218, v218
v_exp_f32 v219, v219
v_exp_f32 v220, v220
v_exp_f32 v221, v221
v_exp_f32 v222, v222
v_exp_f32 v223, v223
v_pk_add_f32 v[216:217], s[54:55], v[216:217]
v_pk_add_f32 v[218:219], s[54:55], v[218:219]
v_pk_add_f32 v[220:221], s[54:55], v[220:221]
v_pk_add_f32 v[222:223], s[54:55], v[222:223]
v_rcp_f32 v216, v216
v_rcp_f32 v217, v217
v_rcp_f32 v218, v218
v_rcp_f32 v219, v219
v_rcp_f32 v220, v220
v_rcp_f32 v221, v221
v_rcp_f32 v222, v222
v_rcp_f32 v223, v223
v_pk_mul_f32 v[216:217], v[216:217], v[48:49]
v_pk_mul_f32 v[218:219], v[218:219], v[50:51]
v_pk_mul_f32 v[220:221], v[220:221], v[64:65]
v_pk_mul_f32 v[222:223], v[222:223], v[66:67]
v_cvt_pk_bf16_f32 v128, v216, v217
v_cvt_pk_bf16_f32 v129, v218, v219
v_cvt_pk_bf16_f32 v130, v220, v221
v_cvt_pk_bf16_f32 v131, v222, v223
ds_write_b128 v232, v[128:131] offset:16384
v_pk_mul_f32 v[216:217], s[52:53], v[52:53]
v_pk_mul_f32 v[218:219], s[52:53], v[54:55]
v_pk_mul_f32 v[220:221], s[52:53], v[68:69]
v_pk_mul_f32 v[222:223], s[52:53], v[70:71]
v_exp_f32 v216, v216
v_exp_f32 v217, v217
v_exp_f32 v218, v218
v_exp_f32 v219, v219
v_exp_f32 v220, v220
v_exp_f32 v221, v221
v_exp_f32 v222, v222
v_exp_f32 v223, v223
v_pk_add_f32 v[216:217], s[54:55], v[216:217]
v_pk_add_f32 v[218:219], s[54:55], v[218:219]
v_pk_add_f32 v[220:221], s[54:55], v[220:221]
v_pk_add_f32 v[222:223], s[54:55], v[222:223]
v_rcp_f32 v216, v216
v_rcp_f32 v217, v217
v_rcp_f32 v218, v218
v_rcp_f32 v219, v219
v_rcp_f32 v220, v220
v_rcp_f32 v221, v221
v_rcp_f32 v222, v222
v_rcp_f32 v223, v223
v_pk_mul_f32 v[216:217], v[216:217], v[52:53]
v_pk_mul_f32 v[218:219], v[218:219], v[54:55]
v_pk_mul_f32 v[220:221], v[220:221], v[68:69]
v_pk_mul_f32 v[222:223], v[222:223], v[70:71]
v_cvt_pk_bf16_f32 v132, v216, v217
v_cvt_pk_bf16_f32 v133, v218, v219
v_cvt_pk_bf16_f32 v134, v220, v221
v_cvt_pk_bf16_f32 v135, v222, v223
ds_write_b128 v232, v[132:135] offset:17408
s_waitcnt vmcnt(0)
s_waitcnt lgkmcnt(0)
s_barrier
buffer_store_dwordx4 v[128:131], v248, s[36:39], s50 offen sc1
buffer_store_dwordx4 v[132:135], v249, s[36:39], s50 offen sc1
PAD9:
s_cbranch_execz PAD10
v_pk_mul_f32 v[216:217], s[52:53], v[56:57]
v_pk_mul_f32 v[218:219], s[52:53], v[58:59]
v_pk_mul_f32 v[220:221], s[52:53], v[72:73]
v_pk_mul_f32 v[222:223], s[52:53], v[74:75]
v_exp_f32 v216, v216
v_exp_f32 v217, v217
v_exp_f32 v218, v218
v_exp_f32 v219, v219
v_exp_f32 v220, v220
v_exp_f32 v221, v221
v_exp_f32 v222, v222
v_exp_f32 v223, v223
v_pk_add_f32 v[216:217], s[54:55], v[216:217]
v_pk_add_f32 v[218:219], s[54:55], v[218:219]
v_pk_add_f32 v[220:221], s[54:55], v[220:221]
v_pk_add_f32 v[222:223], s[54:55], v[222:223]
v_rcp_f32 v216, v216
v_rcp_f32 v217, v217
v_rcp_f32 v218, v218
v_rcp_f32 v219, v219
v_rcp_f32 v220, v220
v_rcp_f32 v221, v221
v_rcp_f32 v222, v222
v_rcp_f32 v223, v223
v_pk_mul_f32 v[216:217], v[216:217], v[56:57]
v_pk_mul_f32 v[218:219], v[218:219], v[58:59]
v_pk_mul_f32 v[220:221], v[220:221], v[72:73]
v_pk_mul_f32 v[222:223], v[222:223], v[74:75]
v_cvt_pk_bf16_f32 v136, v216, v217
v_cvt_pk_bf16_f32 v137, v218, v219
v_cvt_pk_bf16_f32 v138, v220, v221
v_cvt_pk_bf16_f32 v139, v222, v223
buffer_store_dwordx4 v[136:139], v250, s[36:39], s50 offen sc1
ds_write_b128 v232, v[136:139] offset:18432
v_pk_mul_f32 v[216:217], s[52:53], v[60:61]
v_pk_mul_f32 v[218:219], s[52:53], v[62:63]
v_pk_mul_f32 v[220:221], s[52:53], v[76:77]
v_pk_mul_f32 v[222:223], s[52:53], v[78:79]
v_exp_f32 v216, v216
v_exp_f32 v217, v217
v_exp_f32 v218, v218
v_exp_f32 v219, v219
v_exp_f32 v220, v220
v_exp_f32 v221, v221
v_exp_f32 v222, v222
v_exp_f32 v223, v223
v_pk_add_f32 v[216:217], s[54:55], v[216:217]
v_pk_add_f32 v[218:219], s[54:55], v[218:219]
v_pk_add_f32 v[220:221], s[54:55], v[220:221]
v_pk_add_f32 v[222:223], s[54:55], v[222:223]
v_rcp_f32 v216, v216
v_rcp_f32 v217, v217
v_rcp_f32 v218, v218
v_rcp_f32 v219, v219
v_rcp_f32 v220, v220
v_rcp_f32 v221, v221
v_rcp_f32 v222, v222
v_rcp_f32 v223, v223
v_pk_mul_f32 v[216:217], v[216:217], v[60:61]
v_pk_mul_f32 v[218:219], v[218:219], v[62:63]
v_pk_mul_f32 v[220:221], v[220:221], v[76:77]
v_pk_mul_f32 v[222:223], v[222:223], v[78:79]
v_cvt_pk_bf16_f32 v140, v216, v217
v_cvt_pk_bf16_f32 v141, v218, v219
v_cvt_pk_bf16_f32 v142, v220, v221
v_cvt_pk_bf16_f32 v143, v222, v223
buffer_store_dwordx4 v[140:143], v251, s[36:39], s50 offen sc1
ds_write_b128 v232, v[140:143] offset:19456
s_add_u32 s50, s50, 20480
PAD10:
s_cbranch_execz PAD11
v_pk_mul_f32 v[216:217], s[52:53], v[80:81]
v_pk_mul_f32 v[218:219], s[52:53], v[82:83]
v_pk_mul_f32 v[220:221], s[52:53], v[96:97]
v_pk_mul_f32 v[222:223], s[52:53], v[98:99]
v_exp_f32 v216, v216
v_exp_f32 v217, v217
v_exp_f32 v218, v218
v_exp_f32 v219, v219
v_exp_f32 v220, v220
v_exp_f32 v221, v221
v_exp_f32 v222, v222
v_exp_f32 v223, v223
v_pk_add_f32 v[216:217], s[54:55], v[216:217]
v_pk_add_f32 v[218:219], s[54:55], v[218:219]
v_pk_add_f32 v[220:221], s[54:55], v[220:221]
v_pk_add_f32 v[222:223], s[54:55], v[222:223]
v_rcp_f32 v216, v216
v_rcp_f32 v217, v217
v_rcp_f32 v218, v218
v_rcp_f32 v219, v219
v_rcp_f32 v220, v220
v_rcp_f32 v221, v221
v_rcp_f32 v222, v222
v_rcp_f32 v223, v223
v_pk_mul_f32 v[216:217], v[216:217], v[80:81]
v_pk_mul_f32 v[218:219], v[218:219], v[82:83]
v_pk_mul_f32 v[220:221], v[220:221], v[96:97]
v_pk_mul_f32 v[222:223], v[222:223], v[98:99]
v_cvt_pk_bf16_f32 v144, v216, v217
v_cvt_pk_bf16_f32 v145, v218, v219
v_cvt_pk_bf16_f32 v146, v220, v221
v_cvt_pk_bf16_f32 v147, v222, v223
buffer_store_dwordx4 v[144:147], v248, s[36:39], s50 offen sc1
ds_write_b128 v232, v[144:147] offset:32768
v_pk_mul_f32 v[216:217], s[52:53], v[84:85]
v_pk_mul_f32 v[218:219], s[52:53], v[86:87]
v_pk_mul_f32 v[220:221], s[52:53], v[100:101]
v_pk_mul_f32 v[222:223], s[52:53], v[102:103]
v_exp_f32 v216, v216
v_exp_f32 v217, v217
v_exp_f32 v218, v218
v_exp_f32 v219, v219
v_exp_f32 v220, v220
v_exp_f32 v221, v221
v_exp_f32 v222, v222
v_exp_f32 v223, v223
v_pk_add_f32 v[216:217], s[54:55], v[216:217]
v_pk_add_f32 v[218:219], s[54:55], v[218:219]
v_pk_add_f32 v[220:221], s[54:55], v[220:221]
v_pk_add_f32 v[222:223], s[54:55], v[222:223]
v_rcp_f32 v216, v216
v_rcp_f32 v217, v217
v_rcp_f32 v218, v218
v_rcp_f32 v219, v219
v_rcp_f32 v220, v220
v_rcp_f32 v221, v221
v_rcp_f32 v222, v222
v_rcp_f32 v223, v223
v_pk_mul_f32 v[216:217], v[216:217], v[84:85]
v_pk_mul_f32 v[218:219], v[218:219], v[86:87]
v_pk_mul_f32 v[220:221], v[220:221], v[100:101]
v_pk_mul_f32 v[222:223], v[222:223], v[102:103]
v_cvt_pk_bf16_f32 v148, v216, v217
v_cvt_pk_bf16_f32 v149, v218, v219
v_cvt_pk_bf16_f32 v150, v220, v221
v_cvt_pk_bf16_f32 v151, v222, v223
buffer_store_dwordx4 v[148:151], v249, s[36:39], s50 offen sc1
ds_write_b128 v232, v[148:151] offset:33792
PAD11:
s_cbranch_execz PAD12
v_pk_mul_f32 v[216:217], s[52:53], v[88:89]
v_pk_mul_f32 v[218:219], s[52:53], v[90:91]
v_pk_mul_f32 v[220:221], s[52:53], v[104:105]
v_pk_mul_f32 v[222:223], s[52:53], v[106:107]
v_exp_f32 v216, v216
v_exp_f32 v217, v217
v_exp_f32 v218, v218
v_exp_f32 v219, v219
v_exp_f32 v220, v220
v_exp_f32 v221, v221
v_exp_f32 v222, v222
v_exp_f32 v223, v223
v_pk_add_f32 v[216:217], s[54:55], v[216:217]
v_pk_add_f32 v[218:219], s[54:55], v[218:219]
v_pk_add_f32 v[220:221], s[54:55], v[220:221]
v_pk_add_f32 v[222:223], s[54:55], v[222:223]
v_rcp_f32 v216, v216
v_rcp_f32 v217, v217
v_rcp_f32 v218, v218
v_rcp_f32 v219, v219
v_rcp_f32 v220, v220
v_rcp_f32 v221, v221
v_rcp_f32 v222, v222
v_rcp_f32 v223, v223
v_pk_mul_f32 v[216:217], v[216:217], v[88:89]
v_pk_mul_f32 v[218:219], v[218:219], v[90:91]
v_pk_mul_f32 v[220:221], v[220:221], v[104:105]
v_pk_mul_f32 v[222:223], v[222:223], v[106:107]
v_cvt_pk_bf16_f32 v152, v216, v217
v_cvt_pk_bf16_f32 v153, v218, v219
v_cvt_pk_bf16_f32 v154, v220, v221
v_cvt_pk_bf16_f32 v155, v222, v223
buffer_store_dwordx4 v[152:155], v250, s[36:39], s50 offen sc1
ds_write_b128 v232, v[152:155] offset:34816
v_pk_mul_f32 v[216:217], s[52:53], v[92:93]
v_pk_mul_f32 v[218:219], s[52:53], v[94:95]
v_pk_mul_f32 v[220:221], s[52:53], v[108:109]
v_pk_mul_f32 v[222:223], s[52:53], v[110:111]
v_exp_f32 v216, v216
v_exp_f32 v217, v217
v_exp_f32 v218, v218
v_exp_f32 v219, v219
v_exp_f32 v220, v220
v_exp_f32 v221, v221
v_exp_f32 v222, v222
v_exp_f32 v223, v223
v_pk_add_f32 v[216:217], s[54:55], v[216:217]
v_pk_add_f32 v[218:219], s[54:55], v[218:219]
v_pk_add_f32 v[220:221], s[54:55], v[220:221]
v_pk_add_f32 v[222:223], s[54:55], v[222:223]
v_rcp_f32 v216, v216
v_rcp_f32 v217, v217
v_rcp_f32 v218, v218
v_rcp_f32 v219, v219
v_rcp_f32 v220, v220
v_rcp_f32 v221, v221
v_rcp_f32 v222, v222
v_rcp_f32 v223, v223
v_pk_mul_f32 v[216:217], v[216:217], v[92:93]
v_pk_mul_f32 v[218:219], v[218:219], v[94:95]
v_pk_mul_f32 v[220:221], v[220:221], v[108:109]
v_pk_mul_f32 v[222:223], v[222:223], v[110:111]
v_cvt_pk_bf16_f32 v156, v216, v217
v_cvt_pk_bf16_f32 v157, v218, v219
v_cvt_pk_bf16_f32 v158, v220, v221
v_cvt_pk_bf16_f32 v159, v222, v223
buffer_store_dwordx4 v[156:159], v251, s[36:39], s50 offen sc1
ds_write_b128 v232, v[156:159] offset:35840
ds_read_b64_tr_b16 v[176:177], v236 offset:0
ds_read_b64_tr_b16 v[178:179], v236 offset:4096
ds_read_b128 v[160:163], v235 offset:0
ds_read_b128 v[164:167], v235 offset:1024
ds_read_b128 v[168:171], v235 offset:2048
ds_read_b128 v[172:175], v235 offset:3072
ds_read_b64_tr_b16 v[180:181], v237 offset:0
ds_read_b64_tr_b16 v[182:183], v237 offset:4096
ds_read_b64_tr_b16 v[184:185], v238 offset:0
ds_read_b64_tr_b16 v[186:187], v238 offset:4096
ds_read_b64_tr_b16 v[188:189], v239 offset:0
ds_read_b64_tr_b16 v[190:191], v239 offset:4096
PAD12:
s_cbranch_execz PAD13
v_pk_mul_f32 v[216:217], s[52:53], v[112:113]
v_pk_mul_f32 v[218:219], s[52:53], v[114:115]
v_pk_mul_f32 v[220:221], s[52:53], v[116:117]
v_pk_mul_f32 v[222:223], s[52:53], v[118:119]
v_exp_f32 v216, v216
v_exp_f32 v217, v217
v_exp_f32 v218, v218
v_exp_f32 v219, v219
v_exp_f32 v220, v220
v_exp_f32 v221, v221
v_exp_f32 v222, v222
v_exp_f32 v223, v223
v_pk_add_f32 v[216:217], s[54:55], v[216:217]
v_pk_add_f32 v[218:219], s[54:55], v[218:219]
v_pk_add_f32 v[220:221], s[54:55], v[220:221]
v_pk_add_f32 v[222:223], s[54:55], v[222:223]
v_rcp_f32 v216, v216
v_rcp_f32 v217, v217
v_rcp_f32 v218, v218
v_rcp_f32 v219, v219
v_rcp_f32 v220, v220
v_rcp_f32 v221, v221
v_rcp_f32 v222, v222
v_rcp_f32 v223, v223
v_pk_mul_f32 v[216:217], v[216:217], v[112:113]
v_pk_mul_f32 v[218:219], v[218:219], v[114:115]
v_pk_mul_f32 v[220:221], v[220:221], v[116:117]
v_pk_mul_f32 v[222:223], v[222:223], v[118:119]
v_cvt_pk_bf16_f32 v224, v216, v217
v_cvt_pk_bf16_f32 v225, v218, v219
v_cvt_pk_bf16_f32 v226, v220, v221
v_cvt_pk_bf16_f32 v227, v222, v223
s_nop 1
v_permlane16_swap_b32 v224, v226
v_permlane16_swap_b32 v225, v227
buffer_store_dwordx4 v[224:227], v233, s[36:39], s51 offen sc1
v_pk_mul_f32 v[216:217], s[52:53], v[120:121]
v_pk_mul_f32 v[218:219], s[52:53], v[122:123]
v_pk_mul_f32 v[220:221], s[52:53], v[124:125]
v_pk_mul_f32 v[222:223], s[52:53], v[126:127]
v_exp_f32 v216, v216
v_exp_f32 v217, v217
v_exp_f32 v218, v218
v_exp_f32 v219, v219
v_exp_f32 v220, v220
v_exp_f32 v221, v221
v_exp_f32 v222, v222
v_exp_f32 v223, v223
v_pk_add_f32 v[216:217], s[54:55], v[216:217]
v_pk_add_f32 v[218:219], s[54:55], v[218:219]
v_pk_add_f32 v[220:221], s[54:55], v[220:221]
v_pk_add_f32 v[222:223], s[54:55], v[222:223]
v_rcp_f32 v216, v216
v_rcp_f32 v217, v217
v_rcp_f32 v218, v218
v_rcp_f32 v219, v219
v_rcp_f32 v220, v220
v_rcp_f32 v221, v221
v_rcp_f32 v222, v222
v_rcp_f32 v223, v223
v_pk_mul_f32 v[216:217], v[216:217], v[120:121]
v_pk_mul_f32 v[218:219], v[218:219], v[122:123]
v_pk_mul_f32 v[220:221], v[220:221], v[124:125]
v_pk_mul_f32 v[222:223], v[222:223], v[126:127]
v_cvt_pk_bf16_f32 v228, v216, v217
v_cvt_pk_bf16_f32 v229, v218, v219
v_cvt_pk_bf16_f32 v230, v220, v221
v_cvt_pk_bf16_f32 v231, v222, v223
s_nop 1
v_permlane16_swap_b32 v228, v230
v_permlane16_swap_b32 v229, v231
buffer_store_dwordx4 v[228:231], v234, s[36:39], s51 offen sc1
s_mov_b32 s48, 0
s_waitcnt lgkmcnt(0)
v_mfma_f32_16x16x32_bf16 v[16:19], v[176:179], v[160:163], 0
ds_read_b64_tr_b16 v[208:209], v236 offset:8192
v_mfma_f32_16x16x32_bf16 v[20:23], v[176:179], v[164:167], 0
ds_read_b64_tr_b16 v[210:211], v236 offset:12288
v_mfma_f32_16x16x32_bf16 v[24:27], v[176:179], v[168:171], 0
ds_read_b128 v[192:195], v235 offset:8192
v_mfma_f32_16x16x32_bf16 v[28:31], v[176:179], v[172:175], 0
ds_read_b128 v[196:199], v235 offset:9216
v_mfma_f32_16x16x32_bf16 v[44:47], v[180:183], v[172:175], 0
ds_read_b128 v[200:203], v235 offset:10240
v_mfma_f32_16x16x32_bf16 v[40:43], v[180:183], v[168:171], 0
ds_read_b128 v[204:207], v235 offset:11264
v_mfma_f32_16x16x32_bf16 v[36:39], v[180:183], v[164:167], 0
ds_read_b64_tr_b16 v[212:213], v237 offset:8192
v_mfma_f32_16x16x32_bf16 v[32:35], v[180:183], v[160:163], 0
ds_read_b64_tr_b16 v[214:215], v237 offset:12288
v_mfma_f32_16x16x32_bf16 v[48:51], v[184:187], v[160:163], 0
ds_read_b64_tr_b16 v[216:217], v238 offset:8192
v_mfma_f32_16x16x32_bf16 v[52:55], v[184:187], v[164:167], 0
ds_read_b64_tr_b16 v[218:219], v238 offset:12288
v_mfma_f32_16x16x32_bf16 v[56:59], v[184:187], v[168:171], 0
ds_read_b64_tr_b16 v[220:221], v239 offset:8192
v_mfma_f32_16x16x32_bf16 v[60:63], v[184:187], v[172:175], 0
ds_read_b64_tr_b16 v[222:223], v239 offset:12288
v_mfma_f32_16x16x32_bf16 v[76:79], v[188:191], v[172:175], 0
PAD13:
s_cbranch_execz C_wret
v_mfma_f32_16x16x32_bf16 v[72:75], v[188:191], v[168:171], 0
v_mfma_f32_16x16x32_bf16 v[68:71], v[188:191], v[164:167], 0
v_mfma_f32_16x16x32_bf16 v[64:67], v[188:191], v[160:163], 0
s_branch C2_in
.p2align 3
C2_loop:
v_mfma_f32_16x16x32_bf16 v[16:19], v[176:179], v[160:163], v[16:19]
ds_read_b64_tr_b16 v[208:209], v236 offset:8192
v_mfma_f32_16x16x32_bf16 v[20:23], v[176:179], v[164:167], v[20:23]
ds_read_b64_tr_b16 v[210:211], v236 offset:12288
v_mfma_f32_16x16x32_bf16 v[24:27], v[176:179], v[168:171], v[24:27]
ds_read_b128 v[192:195], v235 offset:8192
v_mfma_f32_16x16x32_bf16 v[28:31], v[176:179], v[172:175], v[28:31]
ds_read_b128 v[196:199], v235 offset:9216
v_mfma_f32_16x16x32_bf16 v[44:47], v[180:183], v[172:175], v[44:47]
ds_read_b128 v[200:203], v235 offset:10240
v_mfma_f32_16x16x32_bf16 v[40:43], v[180:183], v[168:171], v[40:43]
ds_read_b128 v[204:207], v235 offset:11264
v_mfma_f32_16x16x32_bf16 v[36:39], v[180:183], v[164:167], v[36:39]
ds_read_b64_tr_b16 v[212:213], v237 offset:8192
v_mfma_f32_16x16x32_bf16 v[32:35], v[180:183], v[160:163], v[32:35]
ds_read_b64_tr_b16 v[214:215], v237 offset:12288
v_mfma_f32_16x16x32_bf16 v[48:51], v[184:187], v[160:163], v[48:51]
ds_read_b64_tr_b16 v[216:217], v238 offset:8192
v_mfma_f32_16x16x32_bf16 v[52:55], v[184:187], v[164:167], v[52:55]
ds_read_b64_tr_b16 v[218:219], v238 offset:12288
v_mfma_f32_16x16x32_bf16 v[56:59], v[184:187], v[168:171], v[56:59]
ds_read_b64_tr_b16 v[220:221], v239 offset:8192
v_mfma_f32_16x16x32_bf16 v[60:63], v[184:187], v[172:175], v[60:63]
ds_read_b64_tr_b16 v[222:223], v239 offset:12288
v_mfma_f32_16x16x32_bf16 v[76:79], v[188:191], v[172:175], v[76:79]
PAD14:
s_cbranch_execz PAD15
v_mfma_f32_16x16x32_bf16 v[72:75], v[188:191], v[168:171], v[72:75]
v_mfma_f32_16x16x32_bf16 v[68:71], v[188:191], v[164:167], v[68:71]
v_mfma_f32_16x16x32_bf16 v[64:67], v[188:191], v[160:163], v[64:67]
C2_in:
s_waitcnt lgkmcnt(0)
s_barrier
v_mfma_f32_16x16x32_bf16 v[16:19], v[208:211], v[192:195], v[16:19]
ds_read_b64_tr_b16 v[176:177], v236 offset:16384
v_mfma_f32_16x16x32_bf16 v[20:23], v[208:211], v[196:199], v[20:23]
ds_read_b64_tr_b16 v[178:179], v236 offset:20480
v_mfma_f32_16x16x32_bf16 v[24:27], v[208:211], v[200:203], v[24:27]
ds_read_b128 v[160:163], v235 offset:16384
v_mfma_f32_16x16x32_bf16 v[28:31], v[208:211], v[204:207], v[28:31]
ds_read_b128 v[164:167], v235 offset:17408
v_mfma_f32_16x16x32_bf16 v[44:47], v[212:215], v[204:207], v[44:47]
ds_read_b128 v[168:171], v235 offset:18432
v_mfma_f32_16x16x32_bf16 v[40:43], v[212:215], v[200:203], v[40:43]
ds_read_b128 v[172:175], v235 offset:19456
v_mfma_f32_16x16x32_bf16 v[36:39], v[212:215], v[196:199], v[36:39]
ds_read_b64_tr_b16 v[180:181], v237 offset:16384
v_mfma_f32_16x16x32_bf16 v[32:35], v[212:215], v[192:195], v[32:35]
ds_read_b64_tr_b16 v[182:183], v237 offset:20480
v_mfma_f32_16x16x32_bf16 v[48:51], v[216:219], v[192:195], v[48:51]
ds_read_b64_tr_b16 v[184:185], v238 offset:16384
v_mfma_f32_16x16x32_bf16 v[52:55], v[216:219], v[196:199], v[52:55]
ds_read_b64_tr_b16 v[186:187], v238 offset:20480
v_mfma_f32_16x16x32_bf16 v[56:59], v[216:219], v[200:203], v[56:59]
ds_read_b64_tr_b16 v[188:189], v239 offset:16384
v_mfma_f32_16x16x32_bf16 v[60:63], v[216:219], v[204:207], v[60:63]
ds_read_b64_tr_b16 v[190:191], v239 offset:20480
v_mfma_f32_16x16x32_bf16 v[76:79], v[220:223], v[204:207], v[76:79]
v_mfma_f32_16x16x32_bf16 v[72:75], v[220:223], v[200:203], v[72:75]
v_mfma_f32_16x16x32_bf16 v[68:71], v[220:223], v[196:199], v[68:71]
s_waitcnt lgkmcnt(0)
v_mfma_f32_16x16x32_bf16 v[64:67], v[220:223], v[192:195], v[64:67]
v_mfma_f32_16x16x32_bf16 v[16:19], v[176:179], v[160:163], v[16:19]
ds_read_b64_tr_b16 v[208:209], v236 offset:24576
v_mfma_f32_16x16x32_bf16 v[20:23], v[176:179], v[164:167], v[20:23]
ds_read_b64_tr_b16 v[210:211], v236 offset:28672
v_mfma_f32_16x16x32_bf16 v[24:27], v[176:179], v[168:171], v[24:27]
ds_read_b128 v[192:195], v235 offset:24576
v_mfma_f32_16x16x32_bf16 v[28:31], v[176:179], v[172:175], v[28:31]
ds_read_b128 v[196:199], v235 offset:25600
v_mfma_f32_16x16x32_bf16 v[44:47], v[180:183], v[172:175], v[44:47]
ds_read_b128 v[200:203], v235 offset:26624
v_mfma_f32_16x16x32_bf16 v[40:43], v[180:183], v[168:171], v[40:43]
ds_read_b128 v[204:207], v235 offset:27648
v_mfma_f32_16x16x32_bf16 v[36:39], v[180:183], v[164:167], v[36:39]
ds_read_b64_tr_b16 v[212:213], v237 offset:24576
v_mfma_f32_16x16x32_bf16 v[32:35], v[180:183], v[160:163], v[32:35]
ds_read_b64_tr_b16 v[214:215], v237 offset:28672
v_mfma_f32_16x16x32_bf16 v[48:51], v[184:187], v[160:163], v[48:51]
ds_read_b64_tr_b16 v[216:217], v238 offset:24576
v_mfma_f32_16x16x32_bf16 v[52:55], v[184:187], v[164:167], v[52:55]
ds_read_b64_tr_b16 v[218:219], v238 offset:28672
v_mfma_f32_16x16x32_bf16 v[56:59], v[184:187], v[168:171], v[56:59]
ds_read_b64_tr_b16 v[220:221], v239 offset:24576
v_mfma_f32_16x16x32_bf16 v[60:63], v[184:187], v[172:175], v[60:63]
ds_read_b64_tr_b16 v[222:223], v239 offset:28672
v_mfma_f32_16x16x32_bf16 v[76:79], v[188:191], v[172:175], v[76:79]
PAD15:
s_cbranch_execz PAD16
v_mfma_f32_16x16x32_bf16 v[72:75], v[188:191], v[168:171], v[72:75]
v_mfma_f32_16x16x32_bf16 v[68:71], v[188:191], v[164:167], v[68:71]
v_mfma_f32_16x16x32_bf16 v[64:67], v[188:191], v[160:163], v[64:67]
s_waitcnt lgkmcnt(0)
s_barrier
v_mfma_f32_16x16x32_bf16 v[16:19], v[208:211], v[192:195], v[16:19]
ds_read_b64_tr_b16 v[176:177], v236 offset:32768
v_mfma_f32_16x16x32_bf16 v[20:23], v[208:211], v[196:199], v[20:23]
ds_read_b64_tr_b16 v[178:179], v236 offset:36864
v_mfma_f32_16x16x32_bf16 v[24:27], v[208:211], v[200:203], v[24:27]
ds_read_b128 v[160:163], v235 offset:32768
v_mfma_f32_16x16x32_bf16 v[28:31], v[208:211], v[204:207], v[28:31]
ds_read_b128 v[164:167], v235 offset:33792
v_mfma_f32_16x16x32_bf16 v[44:47], v[212:215], v[204:207], v[44:47]
ds_read_b128 v[168:171], v235 offset:34816
v_mfma_f32_16x16x32_bf16 v[40:43], v[212:215], v[200:203], v[40:43]
ds_read_b128 v[172:175], v235 offset:35840
v_mfma_f32_16x16x32_bf16 v[36:39], v[212:215], v[196:199], v[36:39]
ds_read_b64_tr_b16 v[180:181], v237 offset:32768
v_mfma_f32_16x16x32_bf16 v[32:35], v[212:215], v[192:195], v[32:35]
ds_read_b64_tr_b16 v[182:183], v237 offset:36864
v_mfma_f32_16x16x32_bf16 v[48:51], v[216:219], v[192:195], v[48:51]
ds_read_b64_tr_b16 v[184:185], v238 offset:32768
v_mfma_f32_16x16x32_bf16 v[52:55], v[216:219], v[196:199], v[52:55]
ds_read_b64_tr_b16 v[186:187], v238 offset:36864
v_mfma_f32_16x16x32_bf16 v[56:59], v[216:219], v[200:203], v[56:59]
ds_read_b64_tr_b16 v[188:189], v239 offset:32768
v_mfma_f32_16x16x32_bf16 v[60:63], v[216:219], v[204:207], v[60:63]
ds_read_b64_tr_b16 v[190:191], v239 offset:36864
v_mfma_f32_16x16x32_bf16 v[76:79], v[220:223], v[204:207], v[76:79]
s_cmp_eq_u32 s48, 0
v_mfma_f32_16x16x32_bf16 v[72:75], v[220:223], v[200:203], v[72:75]
s_cbranch_scc1 H2_1_1
H2_1_1_b:
v_mfma_f32_16x16x32_bf16 v[68:71], v[220:223], v[196:199], v[68:71]
s_waitcnt lgkmcnt(0)
v_mfma_f32_16x16x32_bf16 v[64:67], v[220:223], v[192:195], v[64:67]
v_mfma_f32_16x16x32_bf16 v[16:19], v[176:179], v[160:163], v[16:19]
ds_read_b64_tr_b16 v[208:209], v236 offset:40960
v_mfma_f32_16x16x32_bf16 v[20:23], v[176:179], v[164:167], v[20:23]
ds_read_b64_tr_b16 v[210:211], v236 offset:45056
v_mfma_f32_16x16x32_bf16 v[24:27], v[176:179], v[168:171], v[24:27]
ds_read_b128 v[192:195], v235 offset:40960
v_mfma_f32_16x16x32_bf16 v[28:31], v[176:179], v[172:175], v[28:31]
ds_read_b128 v[196:199], v235 offset:41984
v_mfma_f32_16x16x32_bf16 v[44:47], v[180:183], v[172:175], v[44:47]
ds_read_b128 v[200:203], v235 offset:43008
v_mfma_f32_16x16x32_bf16 v[40:43], v[180:183], v[168:171], v[40:43]
ds_read_b128 v[204:207], v235 offset:44032
v_mfma_f32_16x16x32_bf16 v[36:39], v[180:183], v[164:167], v[36:39]
ds_read_b64_tr_b16 v[212:213], v237 offset:40960
v_mfma_f32_16x16x32_bf16 v[32:35], v[180:183], v[160:163], v[32:35]
ds_read_b64_tr_b16 v[214:215], v237 offset:45056
v_mfma_f32_16x16x32_bf16 v[48:51], v[184:187], v[160:163], v[48:51]
ds_read_b64_tr_b16 v[216:217], v238 offset:40960
v_mfma_f32_16x16x32_bf16 v[52:55], v[184:187], v[164:167], v[52:55]
ds_read_b64_tr_b16 v[218:219], v238 offset:45056
v_mfma_f32_16x16x32_bf16 v[56:59], v[184:187], v[168:171], v[56:59]
ds_read_b64_tr_b16 v[220:221], v239 offset:40960
v_mfma_f32_16x16x32_bf16 v[60:63], v[184:187], v[172:175], v[60:63]
ds_read_b64_tr_b16 v[222:223], v239 offset:45056
v_mfma_f32_16x16x32_bf16 v[76:79], v[188:191], v[172:175], v[76:79]
PAD16:
s_cbranch_execz PAD17
v_mfma_f32_16x16x32_bf16 v[72:75], v[188:191], v[168:171], v[72:75]
v_mfma_f32_16x16x32_bf16 v[68:71], v[188:191], v[164:167], v[68:71]
v_mfma_f32_16x16x32_bf16 v[64:67], v[188:191], v[160:163], v[64:67]
s_waitcnt lgkmcnt(0)
s_barrier
v_mfma_f32_16x16x32_bf16 v[16:19], v[208:211], v[192:195], v[16:19]
ds_read_b64_tr_b16 v[176:177], v236 offset:49152
v_mfma_f32_16x16x32_bf16 v[20:23], v[208:211], v[196:199], v[20:23]
ds_read_b64_tr_b16 v[178:179], v236 offset:53248
v_mfma_f32_16x16x32_bf16 v[24:27], v[208:211], v[200:203], v[24:27]
ds_read_b128 v[160:163], v235 offset:49152
v_mfma_f32_16x16x32_bf16 v[28:31], v[208:211], v[204:207], v[28:31]
ds_read_b128 v[164:167], v235 offset:50176
v_mfma_f32_16x16x32_bf16 v[44:47], v[212:215], v[204:207], v[44:47]
ds_read_b128 v[168:171], v235 offset:51200
v_mfma_f32_16x16x32_bf16 v[40:43], v[212:215], v[200:203], v[40:43]
ds_read_b128 v[172:175], v235 offset:52224
v_mfma_f32_16x16x32_bf16 v[36:39], v[212:215], v[196:199], v[36:39]
ds_read_b64_tr_b16 v[180:181], v237 offset:49152
v_mfma_f32_16x16x32_bf16 v[32:35], v[212:215], v[192:195], v[32:35]
ds_read_b64_tr_b16 v[182:183], v237 offset:53248
v_mfma_f32_16x16x32_bf16 v[48:51], v[216:219], v[192:195], v[48:51]
ds_read_b64_tr_b16 v[184:185], v238 offset:49152
v_mfma_f32_16x16x32_bf16 v[52:55], v[216:219], v[196:199], v[52:55]
ds_read_b64_tr_b16 v[186:187], v238 offset:53248
v_mfma_f32_16x16x32_bf16 v[56:59], v[216:219], v[200:203], v[56:59]
ds_read_b64_tr_b16 v[188:189], v239 offset:49152
v_mfma_f32_16x16x32_bf16 v[60:63], v[216:219], v[204:207], v[60:63]
ds_read_b64_tr_b16 v[190:191], v239 offset:53248
v_mfma_f32_16x16x32_bf16 v[76:79], v[220:223], v[204:207], v[76:79]
v_mfma_f32_16x16x32_bf16 v[72:75], v[220:223], v[200:203], v[72:75]
v_mfma_f32_16x16x32_bf16 v[68:71], v[220:223], v[196:199], v[68:71]
s_waitcnt lgkmcnt(0)
v_mfma_f32_16x16x32_bf16 v[64:67], v[220:223], v[192:195], v[64:67]
v_mfma_f32_16x16x32_bf16 v[16:19], v[176:179], v[160:163], v[16:19]
ds_read_b64_tr_b16 v[208:209], v236 offset:57344
v_mfma_f32_16x16x32_bf16 v[20:23], v[176:179], v[164:167], v[20:23]
ds_read_b64_tr_b16 v[210:211], v236 offset:61440
v_mfma_f32_16x16x32_bf16 v[24:27], v[176:179], v[168:171], v[24:27]
ds_read_b128 v[192:195], v235 offset:57344
v_mfma_f32_16x16x32_bf16 v[28:31], v[176:179], v[172:175], v[28:31]
ds_read_b128 v[196:199], v235 offset:58368
v_mfma_f32_16x16x32_bf16 v[44:47], v[180:183], v[172:175], v[44:47]
ds_read_b128 v[200:203], v235 offset:59392
v_mfma_f32_16x16x32_bf16 v[40:43], v[180:183], v[168:171], v[40:43]
ds_read_b128 v[204:207], v235 offset:60416
v_mfma_f32_16x16x32_bf16 v[36:39], v[180:183], v[164:167], v[36:39]
ds_read_b64_tr_b16 v[212:213], v237 offset:57344
v_mfma_f32_16x16x32_bf16 v[32:35], v[180:183], v[160:163], v[32:35]
ds_read_b64_tr_b16 v[214:215], v237 offset:61440
v_mfma_f32_16x16x32_bf16 v[48:51], v[184:187], v[160:163], v[48:51]
ds_read_b64_tr_b16 v[216:217], v238 offset:57344
v_mfma_f32_16x16x32_bf16 v[52:55], v[184:187], v[164:167], v[52:55]
ds_read_b64_tr_b16 v[218:219], v238 offset:61440
v_mfma_f32_16x16x32_bf16 v[56:59], v[184:187], v[168:171], v[56:59]
ds_read_b64_tr_b16 v[220:221], v239 offset:57344
v_mfma_f32_16x16x32_bf16 v[60:63], v[184:187], v[172:175], v[60:63]
ds_read_b64_tr_b16 v[222:223], v239 offset:61440
v_mfma_f32_16x16x32_bf16 v[76:79], v[188:191], v[172:175], v[76:79]
PAD17:
s_cbranch_execz PAD18
v_mfma_f32_16x16x32_bf16 v[72:75], v[188:191], v[168:171], v[72:75]
v_mfma_f32_16x16x32_bf16 v[68:71], v[188:191], v[164:167], v[68:71]
v_mfma_f32_16x16x32_bf16 v[64:67], v[188:191], v[160:163], v[64:67]
s_waitcnt lgkmcnt(0)
s_barrier
v_mfma_f32_16x16x32_bf16 v[16:19], v[208:211], v[192:195], v[16:19]
ds_read_b64_tr_b16 v[176:177], v236 offset:0
v_mfma_f32_16x16x32_bf16 v[20:23], v[208:211], v[196:199], v[20:23]
ds_read_b64_tr_b16 v[178:179], v236 offset:4096
v_mfma_f32_16x16x32_bf16 v[24:27], v[208:211], v[200:203], v[24:27]
ds_read_b128 v[160:163], v235 offset:0
v_mfma_f32_16x16x32_bf16 v[28:31], v[208:211], v[204:207], v[28:31]
ds_read_b128 v[164:167], v235 offset:1024
v_mfma_f32_16x16x32_bf16 v[44:47], v[212:215], v[204:207], v[44:47]
ds_read_b128 v[168:171], v235 offset:2048
v_mfma_f32_16x16x32_bf16 v[40:43], v[212:215], v[200:203], v[40:43]
ds_read_b128 v[172:175], v235 offset:3072
v_mfma_f32_16x16x32_bf16 v[36:39], v[212:215], v[196:199], v[36:39]
ds_read_b64_tr_b16 v[180:181], v237 offset:0
v_mfma_f32_16x16x32_bf16 v[32:35], v[212:215], v[192:195], v[32:35]
ds_read_b64_tr_b16 v[182:183], v237 offset:4096
v_mfma_f32_16x16x32_bf16 v[48:51], v[216:219], v[192:195], v[48:51]
ds_read_b64_tr_b16 v[184:185], v238 offset:0
v_mfma_f32_16x16x32_bf16 v[52:55], v[216:219], v[196:199], v[52:55]
ds_read_b64_tr_b16 v[186:187], v238 offset:4096
v_mfma_f32_16x16x32_bf16 v[56:59], v[216:219], v[200:203], v[56:59]
ds_read_b64_tr_b16 v[188:189], v239 offset:0
v_mfma_f32_16x16x32_bf16 v[60:63], v[216:219], v[204:207], v[60:63]
ds_read_b64_tr_b16 v[190:191], v239 offset:4096
v_mfma_f32_16x16x32_bf16 v[76:79], v[220:223], v[204:207], v[76:79]
s_add_u32 s48, s48, 1
v_mfma_f32_16x16x32_bf16 v[72:75], v[220:223], v[200:203], v[72:75]
s_cmp_lt_u32 s48, 6
v_mfma_f32_16x16x32_bf16 v[68:71], v[220:223], v[196:199], v[68:71]
s_waitcnt lgkmcnt(0)
v_mfma_f32_16x16x32_bf16 v[64:67], v[220:223], v[192:195], v[64:67]
s_cbranch_scc1 C2_loop
ds_read_b64_tr_b16 v[96:97], v238 offset:8192
ds_read_b64_tr_b16 v[98:99], v238 offset:12288
ds_read_b128 v[80:83], v235 offset:8192
ds_read_b128 v[84:87], v235 offset:9216
ds_read_b128 v[88:91], v235 offset:10240
ds_read_b128 v[92:95], v235 offset:11264
ds_read_b64_tr_b16 v[100:101], v239 offset:8192
ds_read_b64_tr_b16 v[102:103], v239 offset:12288
PAD18:
s_cbranch_execz PAD19
s_barrier
v_mfma_f32_16x16x32_bf16 v[48:51], v[184:187], v[160:163], v[48:51]
ds_read_b64_tr_b16 v[208:209], v238 offset:16384
v_mfma_f32_16x16x32_bf16 v[52:55], v[184:187], v[164:167], v[52:55]
ds_read_b64_tr_b16 v[210:211], v238 offset:20480
v_mfma_f32_16x16x32_bf16 v[56:59], v[184:187], v[168:171], v[56:59]
ds_read_b128 v[192:195], v235 offset:16384
v_mfma_f32_16x16x32_bf16 v[60:63], v[184:187], v[172:175], v[60:63]
ds_read_b128 v[196:199], v235 offset:17408
v_mfma_f32_16x16x32_bf16 v[76:79], v[188:191], v[172:175], v[76:79]
ds_read_b128 v[200:203], v235 offset:18432
v_mfma_f32_16x16x32_bf16 v[72:75], v[188:191], v[168:171], v[72:75]
ds_read_b128 v[204:207], v235 offset:19456
v_mfma_f32_16x16x32_bf16 v[68:71], v[188:191], v[164:167], v[68:71]
ds_read_b64_tr_b16 v[212:213], v239 offset:16384
v_mfma_f32_16x16x32_bf16 v[64:67], v[188:191], v[160:163], v[64:67]
ds_read_b64_tr_b16 v[214:215], v239 offset:20480
s_waitcnt lgkmcnt(8)
v_mfma_f32_16x16x32_bf16 v[48:51], v[96:99], v[80:83], v[48:51]
ds_read_b64_tr_b16 v[216:217], v238 offset:24576
v_mfma_f32_16x16x32_bf16 v[52:55], v[96:99], v[84:87], v[52:55]
ds_read_b64_tr_b16 v[218:219], v238 offset:28672
v_mfma_f32_16x16x32_bf16 v[56:59], v[96:99], v[88:91], v[56:59]
ds_read_b128 v[104:107], v235 offset:24576
v_mfma_f32_16x16x32_bf16 v[60:63], v[96:99], v[92:95], v[60:63]
ds_read_b128 v[108:111], v235 offset:25600
v_mfma_f32_16x16x32_bf16 v[76:79], v[100:103], v[92:95], v[76:79]
ds_read_b128 v[112:115], v235 offset:26624
v_mfma_f32_16x16x32_bf16 v[72:75], v[100:103], v[88:91], v[72:75]
ds_read_b128 v[116:119], v235 offset:27648
v_mfma_f32_16x16x32_bf16 v[68:71], v[100:103], v[84:87], v[68:71]
ds_read_b64_tr_b16 v[220:221], v239 offset:24576
v_mfma_f32_16x16x32_bf16 v[64:67], v[100:103], v[80:83], v[64:67]
ds_read_b64_tr_b16 v[222:223], v239 offset:28672
s_waitcnt lgkmcnt(8)
s_barrier
v_mfma_f32_16x16x32_bf16 v[48:51], v[208:211], v[192:195], v[48:51]
ds_read_b64_tr_b16 v[184:185], v238 offset:32768
v_mfma_f32_16x16x32_bf16 v[52:55], v[208:211], v[196:199], v[52:55]
ds_read_b64_tr_b16 v[186:187], v238 offset:36864
v_mfma_f32_16x16x32_bf16 v[56:59], v[208:211], v[200:203], v[56:59]
ds_read_b128 v[160:163], v235 offset:32768
v_mfma_f32_16x16x32_bf16 v[60:63], v[208:211], v[204:207], v[60:63]
ds_read_b128 v[164:167], v235 offset:33792
v_mfma_f32_16x16x32_bf16 v[76:79], v[212:215], v[204:207], v[76:79]
ds_read_b128 v[168:171], v235 offset:34816
v_mfma_f32_16x16x32_bf16 v[72:75], v[212:215], v[200:203], v[72:75]
ds_read_b128 v[172:175], v235 offset:35840
v_mfma_f32_16x16x32_bf16 v[68:71], v[212:215], v[196:199], v[68:71]
ds_read_b64_tr_b16 v[188:189], v239 offset:32768
v_mfma_f32_16x16x32_bf16 v[64:67], v[212:215], v[192:195], v[64:67]
ds_read_b64_tr_b16 v[190:191], v239 offset:36864
s_waitcnt lgkmcnt(8)
v_mfma_f32_16x16x32_bf16 v[48:51], v[216:219], v[104:107], v[48:51]
ds_read_b64_tr_b16 v[96:97], v238 offset:40960
v_mfma_f32_16x16x32_bf16 v[52:55], v[216:219], v[108:111], v[52:55]
ds_read_b64_tr_b16 v[98:99], v238 offset:45056
v_mfma_f32_16x16x32_bf16 v[56:59], v[216:219], v[112:115], v[56:59]
ds_read_b128 v[80:83], v235 offset:40960
v_mfma_f32_16x16x32_bf16 v[60:63], v[216:219], v[116:119], v[60:63]
ds_read_b128 v[84:87], v235 offset:41984
v_mfma_f32_16x16x32_bf16 v[76:79], v[220:223], v[116:119], v[76:79]
ds_read_b128 v[88:91], v235 offset:43008
v_mfma_f32_16x16x32_bf16 v[72:75], v[220:223], v[112:115], v[72:75]
ds_read_b128 v[92:95], v235 offset:44032
v_mfma_f32_16x16x32_bf16 v[68:71], v[220:223], v[108:111], v[68:71]
ds_read_b64_tr_b16 v[100:101], v239 offset:40960
v_mfma_f32_16x16x32_bf16 v[64:67], v[220:223], v[104:107], v[64:67]
ds_read_b64_tr_b16 v[102:103], v239 offset:45056
PAD19:
s_cbranch_execz C_wret
s_waitcnt lgkmcnt(8)
s_barrier
v_mfma_f32_16x16x32_bf16 v[48:51], v[184:187], v[160:163], v[48:51]
ds_read_b64_tr_b16 v[208:209], v238 offset:49152
v_mfma_f32_16x16x32_bf16 v[52:55], v[184:187], v[164:167], v[52:55]
ds_read_b64_tr_b16 v[210:211], v238 offset:53248
v_mfma_f32_16x16x32_bf16 v[56:59], v[184:187], v[168:171], v[56:59]
ds_read_b128 v[192:195], v235 offset:49152
v_mfma_f32_16x16x32_bf16 v[60:63], v[184:187], v[172:175], v[60:63]
ds_read_b128 v[196:199], v235 offset:50176
v_mfma_f32_16x16x32_bf16 v[76:79], v[188:191], v[172:175], v[76:79]
ds_read_b128 v[200:203], v235 offset:51200
v_mfma_f32_16x16x32_bf16 v[72:75], v[188:191], v[168:171], v[72:75]
ds_read_b128 v[204:207], v235 offset:52224
v_mfma_f32_16x16x32_bf16 v[68:71], v[188:191], v[164:167], v[68:71]
ds_read_b64_tr_b16 v[212:213], v239 offset:49152
v_mfma_f32_16x16x32_bf16 v[64:67], v[188:191], v[160:163], v[64:67]
ds_read_b64_tr_b16 v[214:215], v239 offset:53248
s_waitcnt lgkmcnt(8)
v_mfma_f32_16x16x32_bf16 v[48:51], v[96:99], v[80:83], v[48:51]
ds_read_b64_tr_b16 v[216:217], v238 offset:57344
v_mfma_f32_16x16x32_bf16 v[52:55], v[96:99], v[84:87], v[52:55]
ds_read_b64_tr_b16 v[218:219], v238 offset:61440
v_mfma_f32_16x16x32_bf16 v[56:59], v[96:99], v[88:91], v[56:59]
ds_read_b128 v[104:107], v235 offset:57344
v_mfma_f32_16x16x32_bf16 v[60:63], v[96:99], v[92:95], v[60:63]
ds_read_b128 v[108:111], v235 offset:58368
v_mfma_f32_16x16x32_bf16 v[76:79], v[100:103], v[92:95], v[76:79]
ds_read_b128 v[112:115], v235 offset:59392
v_mfma_f32_16x16x32_bf16 v[72:75], v[100:103], v[88:91], v[72:75]
ds_read_b128 v[116:119], v235 offset:60416
v_mfma_f32_16x16x32_bf16 v[68:71], v[100:103], v[84:87], v[68:71]
ds_read_b64_tr_b16 v[220:221], v239 offset:57344
v_mfma_f32_16x16x32_bf16 v[64:67], v[100:103], v[80:83], v[64:67]
ds_read_b64_tr_b16 v[222:223], v239 offset:61440
s_mul_i32 s52, s41, -327680
s_add_u32 s52, s52, 163840
s_add_u32 s52, s52, s57
s_mov_b32 s53, -2
s_waitcnt lgkmcnt(0)
s_barrier
v_mfma_f32_16x16x32_bf16 v[48:51], v[208:211], v[192:195], v[48:51]
ds_read_b64_tr_b16 v[184:185], v236 offset:0
v_mfma_f32_16x16x32_bf16 v[64:67], v[212:215], v[192:195], v[64:67]
ds_read_b64_tr_b16 v[186:187], v236 offset:4096
v_mfma_f32_16x16x32_bf16 v[64:67], v[220:223], v[104:107], v[64:67]
ds_read_b128 v[160:163], v235 offset:0
v_mfma_f32_16x16x32_bf16 v[48:51], v[216:219], v[104:107], v[48:51]
ds_read_b128 v[164:167], v235 offset:1024
v_mfma_f32_16x16x32_bf16 v[52:55], v[208:211], v[196:199], v[52:55]
ds_read_b128 v[168:171], v235 offset:2048
v_mfma_f32_16x16x32_bf16 v[68:71], v[212:215], v[196:199], v[68:71]
ds_read_b128 v[172:175], v235 offset:3072
v_mfma_f32_16x16x32_bf16 v[68:71], v[220:223], v[108:111], v[68:71]
ds_read_b64_tr_b16 v[188:189], v237 offset:0
v_mfma_f32_16x16x32_bf16 v[52:55], v[216:219], v[108:111], v[52:55]
ds_read_b64_tr_b16 v[190:191], v237 offset:4096
v_cvt_pk_bf16_f32 v128, v48, v49
v_cvt_pk_bf16_f32 v129, v50, v51
v_cvt_pk_bf16_f32 v130, v64, v65
v_cvt_pk_bf16_f32 v131, v66, v67
v_min_u32 v128, s53, v128
v_min_u32 v129, s53, v129
v_min_u32 v130, s53, v130
v_min_u32 v131, s53, v131
buffer_store_dwordx4 v[128:131], v248, s[36:39], s52 offen sc1
v_mfma_f32_16x16x32_bf16 v[56:59], v[208:211], v[200:203], v[56:59]
ds_read_b64_tr_b16 v[96:97], v236 offset:8192
v_mfma_f32_16x16x32_bf16 v[72:75], v[212:215], v[200:203], v[72:75]
ds_read_b64_tr_b16 v[98:99], v236 offset:12288
v_mfma_f32_16x16x32_bf16 v[72:75], v[220:223], v[112:115], v[72:75]
ds_read_b128 v[80:83], v235 offset:8192
v_mfma_f32_16x16x32_bf16 v[56:59], v[216:219], v[112:115], v[56:59]
ds_read_b128 v[84:87], v235 offset:9216
v_cvt_pk_bf16_f32 v132, v52, v53
v_cvt_pk_bf16_f32 v133, v54, v55
v_cvt_pk_bf16_f32 v134, v68, v69
v_cvt_pk_bf16_f32 v135, v70, v71
v_min_u32 v132, s53, v132
v_min_u32 v133, s53, v133
v_min_u32 v134, s53, v134
v_min_u32 v135, s53, v135
buffer_store_dwordx4 v[132:135], v249, s[36:39], s52 offen sc1
v_mfma_f32_16x16x32_bf16 v[60:63], v[208:211], v[204:207], v[60:63]
ds_read_b128 v[88:91], v235 offset:10240
v_mfma_f32_16x16x32_bf16 v[76:79], v[212:215], v[204:207], v[76:79]
ds_read_b128 v[92:95], v235 offset:11264
v_mfma_f32_16x16x32_bf16 v[76:79], v[220:223], v[116:119], v[76:79]
ds_read_b64_tr_b16 v[100:101], v237 offset:8192
v_mfma_f32_16x16x32_bf16 v[60:63], v[216:219], v[116:119], v[60:63]
ds_read_b64_tr_b16 v[102:103], v237 offset:12288
v_cvt_pk_bf16_f32 v136, v56, v57
v_cvt_pk_bf16_f32 v137, v58, v59
v_cvt_pk_bf16_f32 v138, v72, v73
v_cvt_pk_bf16_f32 v139, v74, v75
v_min_u32 v136, s53, v136
v_min_u32 v137, s53, v137
v_min_u32 v138, s53, v138
v_min_u32 v139, s53, v139
buffer_store_dwordx4 v[136:139], v250, s[36:39], s52 offen sc1
PAD20:
s_cbranch_execz PAD21
s_waitcnt lgkmcnt(0)
s_barrier
v_mfma_f32_16x16x32_bf16 v[16:19], v[184:187], v[160:163], v[16:19]
ds_read_b64_tr_b16 v[208:209], v236 offset:16384
v_mfma_f32_16x16x32_bf16 v[20:23], v[184:187], v[164:167], v[20:23]
ds_read_b64_tr_b16 v[210:211], v236 offset:20480
v_mfma_f32_16x16x32_bf16 v[24:27], v[184:187], v[168:171], v[24:27]
ds_read_b128 v[192:195], v235 offset:16384
v_cvt_pk_bf16_f32 v140, v60, v61
v_cvt_pk_bf16_f32 v141, v62, v63
v_cvt_pk_bf16_f32 v142, v76, v77
v_cvt_pk_bf16_f32 v143, v78, v79
v_min_u32 v140, s53, v140
v_min_u32 v141, s53, v141
v_min_u32 v142, s53, v142
v_min_u32 v143, s53, v143
buffer_store_dwordx4 v[140:143], v251, s[36:39], s52 offen sc1
v_mfma_f32_16x16x32_bf16 v[28:31], v[184:187], v[172:175], v[28:31]
ds_read_b128 v[196:199], v235 offset:17408
v_mfma_f32_16x16x32_bf16 v[44:47], v[188:191], v[172:175], v[44:47]
ds_read_b128 v[200:203], v235 offset:18432
v_mfma_f32_16x16x32_bf16 v[40:43], v[188:191], v[168:171], v[40:43]
ds_read_b128 v[204:207], v235 offset:19456
v_mfma_f32_16x16x32_bf16 v[36:39], v[188:191], v[164:167], v[36:39]
ds_read_b64_tr_b16 v[212:213], v237 offset:16384
v_mfma_f32_16x16x32_bf16 v[32:35], v[188:191], v[160:163], v[32:35]
ds_read_b64_tr_b16 v[214:215], v237 offset:20480
v_mfma_f32_16x16x32_bf16 v[16:19], v[96:99], v[80:83], v[16:19]
ds_read_b64_tr_b16 v[216:217], v236 offset:24576
v_mfma_f32_16x16x32_bf16 v[20:23], v[96:99], v[84:87], v[20:23]
ds_read_b64_tr_b16 v[218:219], v236 offset:28672
v_mfma_f32_16x16x32_bf16 v[24:27], v[96:99], v[88:91], v[24:27]
ds_read_b128 v[104:107], v235 offset:24576
v_mfma_f32_16x16x32_bf16 v[28:31], v[96:99], v[92:95], v[28:31]
ds_read_b128 v[108:111], v235 offset:25600
v_mfma_f32_16x16x32_bf16 v[44:47], v[100:103], v[92:95], v[44:47]
ds_read_b128 v[112:115], v235 offset:26624
v_mfma_f32_16x16x32_bf16 v[40:43], v[100:103], v[88:91], v[40:43]
ds_read_b128 v[116:119], v235 offset:27648
v_mfma_f32_16x16x32_bf16 v[36:39], v[100:103], v[84:87], v[36:39]
ds_read_b64_tr_b16 v[220:221], v237 offset:24576
v_mfma_f32_16x16x32_bf16 v[32:35], v[100:103], v[80:83], v[32:35]
ds_read_b64_tr_b16 v[222:223], v237 offset:28672
PAD21:
s_cbranch_execz PAD22
s_waitcnt lgkmcnt(8)
v_mfma_f32_16x16x32_bf16 v[16:19], v[208:211], v[192:195], v[16:19]
ds_read_b64_tr_b16 v[184:185], v236 offset:32768
v_mfma_f32_16x16x32_bf16 v[20:23], v[208:211], v[196:199], v[20:23]
ds_read_b64_tr_b16 v[186:187], v236 offset:36864
v_mfma_f32_16x16x32_bf16 v[24:27], v[208:211], v[200:203], v[24:27]
ds_read_b128 v[160:163], v235 offset:32768
v_mfma_f32_16x16x32_bf16 v[28:31], v[208:211], v[204:207], v[28:31]
ds_read_b128 v[164:167], v235 offset:33792
v_mfma_f32_16x16x32_bf16 v[44:47], v[212:215], v[204:207], v[44:47]
ds_read_b128 v[168:171], v235 offset:34816
v_mfma_f32_16x16x32_bf16 v[40:43], v[212:215], v[200:203], v[40:43]
ds_read_b128 v[172:175], v235 offset:35840
v_mfma_f32_16x16x32_bf16 v[36:39], v[212:215], v[196:199], v[36:39]
ds_read_b64_tr_b16 v[188:189], v237 offset:32768
v_mfma_f32_16x16x32_bf16 v[32:35], v[212:215], v[192:195], v[32:35]
ds_read_b64_tr_b16 v[190:191], v237 offset:36864
s_waitcnt lgkmcnt(8)
v_mfma_f32_16x16x32_bf16 v[16:19], v[216:219], v[104:107], v[16:19]
ds_read_b64_tr_b16 v[96:97], v236 offset:40960
v_mfma_f32_16x16x32_bf16 v[20:23], v[216:219], v[108:111], v[20:23]
ds_read_b64_tr_b16 v[98:99], v236 offset:45056
v_mfma_f32_16x16x32_bf16 v[24:27], v[216:219], v[112:115], v[24:27]
ds_read_b128 v[80:83], v235 offset:40960
v_mfma_f32_16x16x32_bf16 v[28:31], v[216:219], v[116:119], v[28:31]
ds_read_b128 v[84:87], v235 offset:41984
v_mfma_f32_16x16x32_bf16 v[44:47], v[220:223], v[116:119], v[44:47]
ds_read_b128 v[88:91], v235 offset:43008
v_mfma_f32_16x16x32_bf16 v[40:43], v[220:223], v[112:115], v[40:43]
ds_read_b128 v[92:95], v235 offset:44032
v_mfma_f32_16x16x32_bf16 v[36:39], v[220:223], v[108:111], v[36:39]
ds_read_b64_tr_b16 v[100:101], v237 offset:40960
v_mfma_f32_16x16x32_bf16 v[32:35], v[220:223], v[104:107], v[32:35]
ds_read_b64_tr_b16 v[102:103], v237 offset:45056
PAD22:
s_cbranch_execz PAD23
s_waitcnt lgkmcnt(8)
v_mfma_f32_16x16x32_bf16 v[16:19], v[184:187], v[160:163], v[16:19]
ds_read_b64_tr_b16 v[208:209], v236 offset:49152
v_mfma_f32_16x16x32_bf16 v[20:23], v[184:187], v[164:167], v[20:23]
ds_read_b64_tr_b16 v[210:211], v236 offset:53248
v_mfma_f32_16x16x32_bf16 v[24:27], v[184:187], v[168:171], v[24:27]
ds_read_b128 v[192:195], v235 offset:49152
v_mfma_f32_16x16x32_bf16 v[28:31], v[184:187], v[172:175], v[28:31]
ds_read_b128 v[196:199], v235 offset:50176
v_mfma_f32_16x16x32_bf16 v[44:47], v[188:191], v[172:175], v[44:47]
ds_read_b128 v[200:203], v235 offset:51200
v_mfma_f32_16x16x32_bf16 v[40:43], v[188:191], v[168:171], v[40:43]
ds_read_b128 v[204:207], v235 offset:52224
v_mfma_f32_16x16x32_bf16 v[36:39], v[188:191], v[164:167], v[36:39]
ds_read_b64_tr_b16 v[212:213], v237 offset:49152
v_mfma_f32_16x16x32_bf16 v[32:35], v[188:191], v[160:163], v[32:35]
ds_read_b64_tr_b16 v[214:215], v237 offset:53248
s_waitcnt lgkmcnt(8)
v_mfma_f32_16x16x32_bf16 v[16:19], v[96:99], v[80:83], v[16:19]
ds_read_b64_tr_b16 v[216:217], v236 offset:57344
v_mfma_f32_16x16x32_bf16 v[20:23], v[96:99], v[84:87], v[20:23]
ds_read_b64_tr_b16 v[218:219], v236 offset:61440
v_mfma_f32_16x16x32_bf16 v[24:27], v[96:99], v[88:91], v[24:27]
ds_read_b128 v[104:107], v235 offset:57344
v_mfma_f32_16x16x32_bf16 v[28:31], v[96:99], v[92:95], v[28:31]
ds_read_b128 v[108:111], v235 offset:58368
v_mfma_f32_16x16x32_bf16 v[44:47], v[100:103], v[92:95], v[44:47]
ds_read_b128 v[112:115], v235 offset:59392
v_mfma_f32_16x16x32_bf16 v[40:43], v[100:103], v[88:91], v[40:43]
ds_read_b128 v[116:119], v235 offset:60416
v_mfma_f32_16x16x32_bf16 v[36:39], v[100:103], v[84:87], v[36:39]
ds_read_b64_tr_b16 v[220:221], v237 offset:57344
v_mfma_f32_16x16x32_bf16 v[32:35], v[100:103], v[80:83], v[32:35]
ds_read_b64_tr_b16 v[222:223], v237 offset:61440
s_waitcnt lgkmcnt(8)
v_mfma_f32_16x16x32_bf16 v[16:19], v[208:211], v[192:195], v[16:19]
buffer_load_dwordx4 v[80:83], v248, s[36:39], s57 offen sc1
v_mfma_f32_16x16x32_bf16 v[20:23], v[208:211], v[196:199], v[20:23]
buffer_load_dwordx4 v[84:87], v249, s[36:39], s57 offen sc1
v_mfma_f32_16x16x32_bf16 v[24:27], v[208:211], v[200:203], v[24:27]
buffer_load_dwordx4 v[88:91], v250, s[36:39], s57 offen sc1
v_mfma_f32_16x16x32_bf16 v[28:31], v[208:211], v[204:207], v[28:31]
buffer_load_dwordx4 v[92:95], v251, s[36:39], s57 offen sc1
v_mfma_f32_16x16x32_bf16 v[44:47], v[212:215], v[204:207], v[44:47]
v_bfe_u32 v14, v2, 4, 1
v_lshrrev_b32 v13, 5, v2
v_mfma_f32_16x16x32_bf16 v[40:43], v[212:215], v[200:203], v[40:43]
v_lshl_add_u32 v13, v14, 1, v13
v_bfe_u32 v14, v2, 1, 2
v_mfma_f32_16x16x32_bf16 v[36:39], v[212:215], v[196:199], v[36:39]
v_xor_b32 v13, v13, v14
v_and_b32 v14, 15, v2
v_mfma_f32_16x16x32_bf16 v[32:35], v[212:215], v[192:195], v[32:35]
v_lshlrev_b32 v14, 6, v14
s_lshl_b32 s52, s3, 12
s_waitcnt lgkmcnt(0)
v_mfma_f32_16x16x32_bf16 v[16:19], v[216:219], v[104:107], v[16:19]
v_lshl_add_u32 v14, v13, 4, v14
s_add_u32 s52, s52, 131072
v_mfma_f32_16x16x32_bf16 v[20:23], v[216:219], v[108:111], v[20:23]
v_add_u32 v240, s52, v14
v_add_u32 v241, s52, v3
v_mfma_f32_16x16x32_bf16 v[24:27], v[216:219], v[112:115], v[24:27]
v_bfe_u32 v14, v2, 3, 2
v_and_b32 v13, 3, v2
v_mfma_f32_16x16x32_bf16 v[28:31], v[216:219], v[116:119], v[28:31]
v_xor_b32 v13, v13, v14
v_lshrrev_b32 v14, 2, v2
v_mfma_f32_16x16x32_bf16 v[44:47], v[220:223], v[116:119], v[44:47]
v_lshlrev_b32 v14, 11, v14
v_lshl_add_u32 v13, v13, 4, v14
v_mfma_f32_16x16x32_bf16 v[40:43], v[220:223], v[112:115], v[40:43]
s_lshl_b32 s59, s40, 1
s_add_u32 s59, s59, s46
s_lshl_b32 s59, s59, 17
s_lshl_b32 s52, s63, 8
s_add_u32 s59, s59, s52
v_mfma_f32_16x16x32_bf16 v[36:39], v[220:223], v[108:111], v[36:39]
s_lshl_b32 s52, s41, 7
s_add_u32 s59, s59, s52
s_lshl_b32 s52, s47, 6
s_add_u32 s59, s59, s52
s_mov_b32 s58, 0
v_mfma_f32_16x16x32_bf16 v[32:35], v[220:223], v[104:107], v[32:35]
PAD23:
s_cbranch_execz PAD24
s_branch C3_chk
C3_poll:
buffer_load_dwordx4 v[80:83], v248, s[36:39], s57 offen sc1
buffer_load_dwordx4 v[84:87], v249, s[36:39], s57 offen sc1
buffer_load_dwordx4 v[88:91], v250, s[36:39], s57 offen sc1
buffer_load_dwordx4 v[92:95], v251, s[36:39], s57 offen sc1
C3_chk:
s_add_u32 s58, s58, 1
s_waitcnt vmcnt(0)
v_max3_u32 v14, v80, v81, v82
v_max3_u32 v14, v14, v83, v84
v_max3_u32 v14, v14, v85, v86
v_max3_u32 v14, v14, v87, v88
v_max3_u32 v14, v14, v89, v90
v_max3_u32 v14, v14, v91, v92
v_max3_u32 v14, v14, v93, v94
v_max_u32 v14, v14, v95
v_cmp_eq_u32 vcc, -1, v14
s_cmp_lt_u32 s58, 131072
s_cselect_b64 s[60:61], -1, 0
s_and_b64 vcc, vcc, s[60:61]
s_cbranch_scc1 C3_poll
C3_ok:
s_mov_b32 s53, 0xffff0000
v_lshlrev_b32 v216, 16, v80
v_and_b32 v217, s53, v80
v_pk_add_f32 v[16:17], v[16:17], v[216:217]
v_cvt_pk_bf16_f32 v128, v16, v17
v_lshlrev_b32 v216, 16, v81
v_and_b32 v217, s53, v81
v_pk_add_f32 v[18:19], v[18:19], v[216:217]
v_cvt_pk_bf16_f32 v129, v18, v19
v_lshlrev_b32 v216, 16, v82
v_and_b32 v217, s53, v82
v_pk_add_f32 v[32:33], v[32:33], v[216:217]
v_cvt_pk_bf16_f32 v130, v32, v33
v_lshlrev_b32 v216, 16, v83
v_and_b32 v217, s53, v83
v_pk_add_f32 v[34:35], v[34:35], v[216:217]
v_cvt_pk_bf16_f32 v131, v34, v35
s_nop 1
v_permlane16_swap_b32 v128, v130
v_permlane16_swap_b32 v129, v131
ds_write_b128 v240, v[128:131] offset:0
ds_read_b128 v[144:147], v241 offset:0
PAD24:
s_cbranch_execz PAD25
v_lshlrev_b32 v216, 16, v84
v_and_b32 v217, s53, v84
v_pk_add_f32 v[20:21], v[20:21], v[216:217]
v_cvt_pk_bf16_f32 v132, v20, v21
v_lshlrev_b32 v216, 16, v85
v_and_b32 v217, s53, v85
v_pk_add_f32 v[22:23], v[22:23], v[216:217]
v_cvt_pk_bf16_f32 v133, v22, v23
v_lshlrev_b32 v216, 16, v86
v_and_b32 v217, s53, v86
v_pk_add_f32 v[36:37], v[36:37], v[216:217]
v_cvt_pk_bf16_f32 v134, v36, v37
v_lshlrev_b32 v216, 16, v87
v_and_b32 v217, s53, v87
v_pk_add_f32 v[38:39], v[38:39], v[216:217]
v_cvt_pk_bf16_f32 v135, v38, v39
s_nop 1
v_permlane16_swap_b32 v132, v134
v_permlane16_swap_b32 v133, v135
ds_write_b128 v240, v[132:135] offset:1024
ds_read_b128 v[148:151], v241 offset:1024
s_waitcnt lgkmcnt(2)
buffer_store_dwordx4 v[144:147], v13, s[28:31], s59 offen sc1
s_add_u32 s59, s59, 0x8000
v_lshlrev_b32 v216, 16, v88
v_and_b32 v217, s53, v88
v_pk_add_f32 v[24:25], v[24:25], v[216:217]
v_cvt_pk_bf16_f32 v136, v24, v25
v_lshlrev_b32 v216, 16, v89
v_and_b32 v217, s53, v89
v_pk_add_f32 v[26:27], v[26:27], v[216:217]
v_cvt_pk_bf16_f32 v137, v26, v27
v_lshlrev_b32 v216, 16, v90
v_and_b32 v217, s53, v90
v_pk_add_f32 v[40:41], v[40:41], v[216:217]
v_cvt_pk_bf16_f32 v138, v40, v41
v_lshlrev_b32 v216, 16, v91
v_and_b32 v217, s53, v91
v_pk_add_f32 v[42:43], v[42:43], v[216:217]
v_cvt_pk_bf16_f32 v139, v42, v43
s_nop 1
v_permlane16_swap_b32 v136, v138
v_permlane16_swap_b32 v137, v139
ds_write_b128 v240, v[136:139] offset:2048
ds_read_b128 v[152:155], v241 offset:2048
s_waitcnt lgkmcnt(2)
buffer_store_dwordx4 v[148:151], v13, s[28:31], s59 offen sc1
s_add_u32 s59, s59, 0x8000
v_lshlrev_b32 v216, 16, v92
v_and_b32 v217, s53, v92
v_pk_add_f32 v[28:29], v[28:29], v[216:217]
v_cvt_pk_bf16_f32 v140, v28, v29
v_lshlrev_b32 v216, 16, v93
v_and_b32 v217, s53, v93
v_pk_add_f32 v[30:31], v[30:31], v[216:217]
v_cvt_pk_bf16_f32 v141, v30, v31
v_lshlrev_b32 v216, 16, v94
v_and_b32 v217, s53, v94
v_pk_add_f32 v[44:45], v[44:45], v[216:217]
v_cvt_pk_bf16_f32 v142, v44, v45
v_lshlrev_b32 v216, 16, v95
v_and_b32 v217, s53, v95
v_pk_add_f32 v[46:47], v[46:47], v[216:217]
v_cvt_pk_bf16_f32 v143, v46, v47
s_nop 1
v_permlane16_swap_b32 v140, v142
v_permlane16_swap_b32 v141, v143
ds_write_b128 v240, v[140:143] offset:3072
ds_read_b128 v[156:159], v241 offset:3072
s_waitcnt lgkmcnt(2)
buffer_store_dwordx4 v[152:155], v13, s[28:31], s59 offen sc1
s_add_u32 s59, s59, 0x8000
s_waitcnt lgkmcnt(0)
buffer_store_dwordx4 v[156:159], v13, s[28:31], s59 offen sc1
s_endpgm
PAD25:
s_cbranch_execz PAD26
s_endpgm
H1_clr:
buffer_store_dwordx4 v[244:247], v248, s[36:39], s57 offen sc1
buffer_store_dwordx4 v[244:247], v249, s[36:39], s57 offen sc1
buffer_store_dwordx4 v[244:247], v250, s[36:39], s57 offen sc1
buffer_store_dwordx4 v[244:247], v251, s[36:39], s57 offen sc1
s_branch H1_clr_b
H1_ack:
s_waitcnt vmcnt(0)
s_branch H1_ack_b
H1_late:
PAD26:
s_cbranch_execz C_wret
s_lshl_b32 s52, s46, 12
v_add_u32 v235, s52, v3
v_lshrrev_b32 v13, 5, v2
v_lshlrev_b32 v13, 11, v13
v_bfe_u32 v14, v2, 4, 1
v_mul_u32_u24 v14, 288, v14
v_add_u32 v13, v13, v14
v_bfe_u32 v15, v2, 2, 2
v_lshl_add_u32 v13, v15, 6, v13
v_and_b32 v15, 3, v2
v_lshl_add_u32 v13, v15, 3, v13
s_lshl_b32 s52, s41, 1
s_add_u32 s52, s52, s47
s_lshl_b32 s52, s52, 9
s_add_u32 s52, s52, 65536
v_add_u32 v236, s52, v13
v_xor_b32 v237, 32, v236
v_xor_b32 v238, 0x400, v236
v_xor_b32 v239, 0x420, v236
s_mul_i32 s50, s40, 112
s_mul_i32 s51, s43, 7
s_add_u32 s50, s50, s51
s_and_b32 s52, s42, 1
s_xor_b32 s53, s52, 1
s_mul_i32 s53, s53, 6
s_add_u32 s51, s50, s53
s_add_u32 s50, s50, s52
s_add_u32 s50, s50, s47
s_mul_i32 s52, s46, 5120
s_mul_i32 s50, s50, 10240
s_add_u32 s50, s50, s52
s_mul_i32 s51, s51, 10240
s_add_u32 s51, s51, s52
s_lshl_b32 s52, s46, 12
s_lshl_b32 s53, s47, 13
s_add_u32 s52, s52, s53
v_add_u32 v232, s52, v3
v_bfe_u32 v13, v2, 4, 1
v_lshlrev_b32 v13, 3, v13
v_lshrrev_b32 v14, 5, v2
v_lshl_add_u32 v13, v14, 1, v13
v_bfe_u32 v14, v2, 3, 1
s_lshl_b32 s52, s47, 2
v_add3_u32 v13, v13, v14, s52
v_add_u32 v14, 16, v13
v_and_b32 v15, 7, v2
v_lshlrev_b32 v15, 4, v15
v_add_u32 v12, 4, v13
v_mul_u32_u24 v12, 37, v12
v_lshrrev_b32 v12, 8, v12
v_add_u32 v12, v12, v13
v_lshlrev_b32 v233, 7, v12
v_add_u32 v12, 4, v14
v_mul_u32_u24 v12, 37, v12
v_lshrrev_b32 v12, 8, v12
v_add_u32 v12, v12, v14
v_lshlrev_b32 v234, 7, v12
v_add_u32 v233, v233, v15
v_add_u32 v234, v234, v15
s_mov_b32 s52, 0xbfb8aa3b
s_mov_b32 s53, 0xbfb8aa3b
s_mov_b32 s54, 1.0
s_mov_b32 s55, 1.0
s_branch H1_late_b
H1_pf1:
v_xor_b32 v252, 0x400, v252
s_nop 0
buffer_load_dword v253, v252, s[16:19], 0 offen
s_cmp_ge_u32 s3, 4
s_cbranch_scc1 C_walked
s_mov_b64 exec, 0
s_cmp_eq_u32 s3, 0
s_cbranch_scc1 PAD0
s_cmp_eq_u32 s3, 1
s_cbranch_scc1 PAD7
s_cmp_eq_u32 s3, 2
s_cbranch_scc1 PAD14
s_branch PAD20
C_wret:
s_mov_b64 exec, -1
C_walked:
s_branch H1_pf1_b
H1_pf:
v_min_u32 v15, 55, v2
v_lshlrev_b32 v15, 7, v15
s_lshl_b32 s58, s2, 2
s_add_u32 s58, s58, s3
s_mul_i32 s58, s58, 7168
buffer_load_dword v255, v15, s[24:27], s58 offen
s_branch H1_pf_b
H2_1_1:
s_waitcnt vmcnt(0)
s_branch H2_1_1_b
L_end:
s_endpgm
.section .rodata,"a"
.p2align 6
.amdhsa_kernel standalone__dense_activation_silu__prompt_kernel
  .amdhsa_next_free_vgpr 256
  .amdhsa_next_free_sgpr 96
  .amdhsa_accum_offset 256
  .amdhsa_group_segment_fixed_size 0
  .amdhsa_kernarg_size 48
  .amdhsa_user_sgpr_count 2
  .amdhsa_user_sgpr_kernarg_segment_ptr 1
  .amdhsa_system_sgpr_workgroup_id_x 1
.end_amdhsa_kernel
```
